```python
import torch

def _softmax(x, axis=-1):
    return torch.softmax(x, dim=axis)
def _gelu(x):
    return torch.nn.functional.gelu(x, approximate="tanh")
def _silu(x):
    return torch.nn.functional.silu(x)
def _sigmoid(x):
    return torch.sigmoid(x)
def _layernorm(x, axis=-1, eps=1e-5):
    m = x.mean(dim=axis, keepdim=True)
    v = x.var(dim=axis, keepdim=True, unbiased=False)
    return (x - m) / torch.sqrt(v + eps)
def _scatter_add(tgt, idx, src, axis=0):
    return tgt.clone().index_add_(axis, idx, src)
def _segment_sum(src, seg, n):
    out = torch.zeros((n,) + src.shape[1:], dtype=src.dtype)
    return out.index_add_(0, seg, src)
def _pad(x, pw):
    flat = tuple(v for pair in reversed(pw) for v in pair)
    return torch.nn.functional.pad(x, flat)

kernel_name = 'interleave_layers__ssm_conv_h3__ssm_conv_s4d__prompt'

def setup_inputs():

    _w = (lambda a: (lambda t: t.to(torch.bfloat16) if t.is_floating_point() else t)(torch.as_tensor(a)))
    def _A_setup():
        B, S, D = 1, 2048, 512
        ks = 4
        return {
            "q": _w((lambda *s: torch.randn(*s, dtype=torch.bfloat16) * 0.05)(B, S, D)),
            "k": _w((lambda *s: torch.randn(*s, dtype=torch.bfloat16) * 0.4)(B, S, D)),
            "v": _w((lambda *s: torch.randn(*s, dtype=torch.bfloat16) * 0.4)(B, S, D)),
            "shift_k": _w((lambda *s: torch.randn(*s, dtype=torch.bfloat16) * 0.4)(D, ks) * 0.5),
            "ssm_k": _w((lambda *s: torch.randn(*s, dtype=torch.bfloat16) * 0.4)(D, S) * (1.0 / S ** 0.5)),
            "ssm_D": _w((lambda *s: torch.randn(*s, dtype=torch.bfloat16) * 0.4)(D)),
        }
    _A_in = _A_setup()

    def _B_setup():
        Bsz, L, D, N = 1, 2048, 512, 128
        return {
            "u": _w((lambda *s: torch.randn(*s, dtype=torch.bfloat16) * 0.05)(Bsz, L, D)),
            "log_A_real": _w((lambda *s: torch.randn(*s, dtype=torch.bfloat16) * 6.4)(D, N) * 0.5),
            "A_imag": _w((lambda *s: torch.randn(*s, dtype=torch.bfloat16) * 0.05)(D, N) * 3.14),
            "C_real": _w((lambda *s: torch.randn(*s, dtype=torch.bfloat16) * 0.1)(D, N) / N ** 0.5),
            "C_imag": _w((lambda *s: torch.randn(*s, dtype=torch.bfloat16) * 0.1)(D, N) / N ** 0.5),
            "log_dt": _w((lambda *s: torch.randn(*s, dtype=torch.bfloat16) * 0.05)(D) * 0.5 - 4.0),
            "D_skip": _w((lambda *s: torch.randn(*s, dtype=torch.bfloat16) * 0.05)(D)),
        }
    _B_in = _B_setup()

    return {
        "A_q": _A_in["q"],
        "A_k": _A_in["k"],
        "A_v": _A_in["v"],
        "A_shift_k": _A_in["shift_k"],
        "A_ssm_k": _A_in["ssm_k"],
        "A_ssm_D": _A_in["ssm_D"],
        "B_u": _B_in["u"],
        "B_log_A_real": _B_in["log_A_real"],
        "B_A_imag": _B_in["A_imag"],
        "B_C_real": _B_in["C_real"],
        "B_C_imag": _B_in["C_imag"],
        "B_log_dt": _B_in["log_dt"],
        "B_D_skip": _B_in["D_skip"],
    }

def reference(A_q, A_k, A_v, A_shift_k, A_ssm_k, A_ssm_D, B_u, B_log_A_real, B_A_imag, B_C_real, B_C_imag, B_log_dt, B_D_skip):
    def _A_ref(q, k, v, shift_k, ssm_k, ssm_D):
        B, S, D = q.shape
        ks = shift_k.shape[-1]
        k_pad = _pad(k, ((0, 0), (ks - 1, 0), (0, 0)))
        k_shift = torch.zeros_like(k)
        for t in range(ks):
            k_shift = k_shift + k_pad[:, t:t + S, :] * shift_k[:, ks - 1 - t][None, None, :]
        kv = k_shift * v
        L = 2 * S
        kv_pad = _pad(kv, ((0, 0), (0, S), (0, 0)))
        kf_pad = _pad(ssm_k, ((0, 0), (0, S)))
        kv_f = (lambda x, axes=(-2,-1): torch.fft.rfft2(x.float(), dim=axes))(kv_pad[:, None, :, :], axes=(1, 2))
        kf_f = (lambda x, axes=(-2,-1): torch.fft.rfft2(x.float(), dim=axes))(kf_pad[:, None, :], axes=(1, 2))
        kf_f = (lambda x, *d: x.permute(*d))(kf_f, 1, 2, 0)
        y_f = kv_f * kf_f[None, :, :, :]
        y = (lambda x, s, axes=(-2,-1): torch.fft.irfft2(x, s=s, dim=axes).to(torch.bfloat16))(y_f, (1, L), axes=(1, 2))[:, 0, :S, :]
        y = y + kv * ssm_D[None, None, :]
        return q * y

    def _B_ref(u, log_A_real, A_imag, C_real, C_imag, log_dt, D_skip):
        L = u.shape[1]
        dt = torch.exp(log_dt)
        A = -torch.exp(log_A_real) + 1j * A_imag
        C = (C_real + 1j * C_imag) * dt[:, None]
        pos = (lambda x, dt: x.to(dt))(torch.arange(L), log_dt.dtype)
        P = torch.exp((A * dt[:, None])[:, :, None] * pos[None, None, :])
        K = 2.0 * torch.einsum("dn,dnl->dl", C, P).real
        L2 = 2 * L
        u_t = (lambda x, *d: x.permute(*d))(u, 0, 2, 1)
        Kf = (lambda x, *a, **k: torch.fft.rfft(x.float(), *a, **k))(K, L2)
        Uf = (lambda x, *a, **k: torch.fft.rfft(x.float(), *a, **k))(u_t, L2)
        y = (lambda x, *a, **k: torch.fft.irfft(x, *a, **k).to(torch.bfloat16))(Uf * Kf[None, :, :], L2)[:, :, :L]
        y = (lambda x, *d: x.permute(*d))(y, 0, 2, 1)
        return y + u * D_skip[None, None, :]

    x = A_q
    x = x + _A_ref(_layernorm(x, axis=-1), A_k, A_v, A_shift_k, A_ssm_k, A_ssm_D)
    x = x + _B_ref(_layernorm(x, axis=-1), B_log_A_real, B_A_imag, B_C_real, B_C_imag, B_log_dt, B_D_skip)
    x = x + _A_ref(_layernorm(x, axis=-1), A_k, A_v, A_shift_k, A_ssm_k, A_ssm_D)
    x = x + _B_ref(_layernorm(x, axis=-1), B_log_A_real, B_A_imag, B_C_real, B_C_imag, B_log_dt, B_D_skip)
    return x
```

```asm
; @launch kernel=kv_kernel grid=(768,1,1) block=(512,1,1) lds=35328
; @launch kernel=convA_kernel grid=(256,1,1) block=(512,1,1) lds=92800
; @launch kernel=row1_kernel grid=(256,1,1) block=(512,1,1) lds=1024
; @launch kernel=convB1_kernel grid=(256,1,1) block=(512,1,1) lds=92800
; @launch kernel=row2_kernel grid=(256,1,1) block=(512,1,1) lds=1024
; @launch kernel=convB2_kernel grid=(256,1,1) block=(512,1,1) lds=92800
.amdgcn_target "amdgcn-amd-amdhsa--gfx950"
.text
.globl kv_kernel
.p2align 8
.type kv_kernel,@function
kv_kernel:
    s_add_u32 s60, s2, 256
    s_sub_u32 s61, s2, 512
    s_cmp_lt_u32 s2, 512
    s_cselect_b32 s61, s60, s61
    s_cmp_lt_u32 s2, 768
    s_cselect_b32 s2, s61, s2
    s_cmp_ge_u32 s2, 256
    s_cbranch_scc1 L_kv_kgen
    s_load_dwordx4 s[4:7], s[0:1], 8
    s_load_dwordx2 s[8:9], s[0:1], 24
    s_load_dwordx2 s[10:11], s[0:1], 120
    s_load_dwordx2 s[32:33], s[0:1], 0
    s_load_dwordx2 s[34:35], s[0:1], 32
    s_load_dwordx2 s[50:51], s[0:1], 40
    s_load_dwordx2 s[52:53], s[0:1], 96
    s_and_b32 s3, s2, 7
    s_lshl_b32 s3, s3, 5
    s_lshr_b32 s12, s2, 3
    s_add_u32 s3, s3, s12
    v_and_b32 v1, 255, v0
    v_lshrrev_b32 v2, 8, v0
    s_lshl_b32 s13, s3, 3
    v_lshl_add_u32 v3, v2, 2, s13
    v_lshlrev_b32 v4, 10, v3
    v_lshl_add_u32 v4, v1, 2, v4
    v_subrev_u32 v5, 3072, v4
    v_subrev_u32 v6, 2048, v4
    v_subrev_u32 v7, 1024, v4
    v_lshlrev_b32 v8, 4, v1
    v_lshrrev_b32 v9, 2, v1
    v_lshlrev_b32 v9, 15, v9
    v_lshl_add_u32 v9, v3, 4, v9
    v_and_b32 v21, 3, v1
    v_lshl_add_u32 v9, v21, 2, v9
    s_waitcnt lgkmcnt(0)
    s_mov_b32 s16, s4
    s_and_b32 s17, s5, 0xffff
    s_mov_b32 s18, 2097152
    s_mov_b32 s19, 0x00020000
    s_mov_b32 s20, s6
    s_and_b32 s21, s7, 0xffff
    s_mov_b32 s22, 2097152
    s_mov_b32 s23, 0x00020000
    s_mov_b32 s24, s8
    s_and_b32 s25, s9, 0xffff
    s_mov_b32 s26, 4096
    s_mov_b32 s27, 0x00020000
    s_mov_b32 s28, s10
    s_and_b32 s29, s11, 0xffff
    s_mov_b32 s30, 268435456
    s_mov_b32 s31, 0x00020000
    buffer_load_dwordx4 v[24:27], v8, s[24:27], 0 offen
    s_waitcnt vmcnt(0)
    v_lshlrev_b32 v28, 16, v24
    v_and_b32 v29, 0xffff0000, v24
    v_lshlrev_b32 v30, 16, v25
    v_and_b32 v31, 0xffff0000, v25
    v_lshlrev_b32 v32, 16, v26
    v_and_b32 v33, 0xffff0000, v26
    v_lshlrev_b32 v34, 16, v27
    v_and_b32 v35, 0xffff0000, v27
    buffer_load_dword v10, v5, s[16:19], 0 offen
    buffer_load_dword v11, v6, s[16:19], 0 offen
    buffer_load_dword v12, v7, s[16:19], 0 offen
    buffer_load_dword v13, v4, s[16:19], 0 offen
    buffer_load_dword v14, v4, s[16:19], 0 offen offset:1024
    buffer_load_dword v15, v4, s[16:19], 0 offen offset:2048
    buffer_load_dword v16, v4, s[16:19], 0 offen offset:3072
    buffer_load_dword v17, v4, s[20:23], 0 offen
    buffer_load_dword v18, v4, s[20:23], 0 offen offset:1024
    buffer_load_dword v19, v4, s[20:23], 0 offen offset:2048
    buffer_load_dword v20, v4, s[20:23], 0 offen offset:3072
    s_waitcnt vmcnt(4)
    v_lshlrev_b32 v36, 16, v10
    v_and_b32 v44, 0xffff0000, v10
    v_lshlrev_b32 v37, 16, v11
    v_and_b32 v45, 0xffff0000, v11
    v_lshlrev_b32 v38, 16, v12
    v_and_b32 v46, 0xffff0000, v12
    v_lshlrev_b32 v39, 16, v13
    v_and_b32 v47, 0xffff0000, v13
    v_lshlrev_b32 v40, 16, v14
    v_and_b32 v48, 0xffff0000, v14
    v_lshlrev_b32 v41, 16, v15
    v_and_b32 v49, 0xffff0000, v15
    v_lshlrev_b32 v42, 16, v16
    v_and_b32 v50, 0xffff0000, v16
    s_waitcnt vmcnt(0)
    s_cmp_ge_u32 s2, 8
    s_cbranch_scc1 L_kv_nopf2
    s_getpc_b64 s[58:59]
L_pf_base:
    s_sub_u32 s58, s58, L_pf_base-kv_kernel
    s_subb_u32 s59, s59, 0
    v_lshlrev_b32 v22, 7, v0
    v_min_u32 v22, L_code_end-kv_kernel-4, v22
    global_load_dword v69, v22, s[58:59]
L_kv_nopf2:
    s_mov_b32 s36, s32
    s_and_b32 s37, s33, 0xffff
    s_mov_b32 s38, 2097152
    s_mov_b32 s39, 0x00020000
    s_mov_b32 s40, s34
    s_and_b32 s41, s35, 0xffff
    s_mov_b32 s42, 2097152
    s_mov_b32 s43, 0x00020000
    s_lshl_b32 s44, s3, 13
    v_lshrrev_b32 v22, 6, v0
    v_and_b32 v23, 7, v0
    v_lshl_add_u32 v22, v22, 3, v23
    v_lshlrev_b32 v22, 7, v22
    s_mov_b64 exec, 0xff
    buffer_load_dword v64, v22, s[40:43], s44 offen
    buffer_load_dword v65, v22, s[36:39], s44 offen
    s_mov_b64 exec, -1
    v_mul_f32 v54, v36, v31
    v_mul_f32 v55, v44, v35
    v_cvt_pk_bf16_f32 v56, v54, v55
    v_lshlrev_b32 v52, 16, v56
    v_and_b32 v53, 0xffff0000, v56
    v_mul_f32 v54, v37, v30
    v_mul_f32 v55, v45, v34
    v_cvt_pk_bf16_f32 v56, v54, v55
    v_lshlrev_b32 v54, 16, v56
    v_and_b32 v55, 0xffff0000, v56
    v_add_f32 v52, v52, v54
    v_add_f32 v53, v53, v55
    v_cvt_pk_bf16_f32 v56, v52, v53
    v_lshlrev_b32 v52, 16, v56
    v_and_b32 v53, 0xffff0000, v56
    v_mul_f32 v54, v38, v29
    v_mul_f32 v55, v46, v33
    v_cvt_pk_bf16_f32 v56, v54, v55
    v_lshlrev_b32 v54, 16, v56
    v_and_b32 v55, 0xffff0000, v56
    v_add_f32 v52, v52, v54
    v_add_f32 v53, v53, v55
    v_cvt_pk_bf16_f32 v56, v52, v53
    v_lshlrev_b32 v52, 16, v56
    v_and_b32 v53, 0xffff0000, v56
    v_mul_f32 v54, v39, v28
    v_mul_f32 v55, v47, v32
    v_cvt_pk_bf16_f32 v56, v54, v55
    v_lshlrev_b32 v54, 16, v56
    v_and_b32 v55, 0xffff0000, v56
    v_add_f32 v52, v52, v54
    v_add_f32 v53, v53, v55
    v_cvt_pk_bf16_f32 v56, v52, v53
    v_lshlrev_b32 v52, 16, v56
    v_and_b32 v53, 0xffff0000, v56
    v_lshlrev_b32 v54, 16, v17
    v_and_b32 v55, 0xffff0000, v17
    v_mul_f32 v52, v52, v54
    v_mul_f32 v53, v53, v55
    v_cvt_pk_bf16_f32 v60, v52, v53
    v_mul_f32 v54, v37, v31
    v_mul_f32 v55, v45, v35
    v_cvt_pk_bf16_f32 v56, v54, v55
    v_lshlrev_b32 v52, 16, v56
    v_and_b32 v53, 0xffff0000, v56
    v_mul_f32 v54, v38, v30
    v_mul_f32 v55, v46, v34
    v_cvt_pk_bf16_f32 v56, v54, v55
    v_lshlrev_b32 v54, 16, v56
    v_and_b32 v55, 0xffff0000, v56
    v_add_f32 v52, v52, v54
    v_add_f32 v53, v53, v55
    v_cvt_pk_bf16_f32 v56, v52, v53
    v_lshlrev_b32 v52, 16, v56
    v_and_b32 v53, 0xffff0000, v56
    v_mul_f32 v54, v39, v29
    v_mul_f32 v55, v47, v33
    v_cvt_pk_bf16_f32 v56, v54, v55
    v_lshlrev_b32 v54, 16, v56
    v_and_b32 v55, 0xffff0000, v56
    v_add_f32 v52, v52, v54
    v_add_f32 v53, v53, v55
    v_cvt_pk_bf16_f32 v56, v52, v53
    v_lshlrev_b32 v52, 16, v56
    v_and_b32 v53, 0xffff0000, v56
    v_mul_f32 v54, v40, v28
    v_mul_f32 v55, v48, v32
    v_cvt_pk_bf16_f32 v56, v54, v55
    v_lshlrev_b32 v54, 16, v56
    v_and_b32 v55, 0xffff0000, v56
    v_add_f32 v52, v52, v54
    v_add_f32 v53, v53, v55
    v_cvt_pk_bf16_f32 v56, v52, v53
    v_lshlrev_b32 v52, 16, v56
    v_and_b32 v53, 0xffff0000, v56
    v_lshlrev_b32 v54, 16, v18
    v_and_b32 v55, 0xffff0000, v18
    v_mul_f32 v52, v52, v54
    v_mul_f32 v53, v53, v55
    v_cvt_pk_bf16_f32 v61, v52, v53
    v_mul_f32 v54, v38, v31
    v_mul_f32 v55, v46, v35
    v_cvt_pk_bf16_f32 v56, v54, v55
    v_lshlrev_b32 v52, 16, v56
    v_and_b32 v53, 0xffff0000, v56
    v_mul_f32 v54, v39, v30
    v_mul_f32 v55, v47, v34
    v_cvt_pk_bf16_f32 v56, v54, v55
    v_lshlrev_b32 v54, 16, v56
    v_and_b32 v55, 0xffff0000, v56
    v_add_f32 v52, v52, v54
    v_add_f32 v53, v53, v55
    v_cvt_pk_bf16_f32 v56, v52, v53
    v_lshlrev_b32 v52, 16, v56
    v_and_b32 v53, 0xffff0000, v56
    v_mul_f32 v54, v40, v29
    v_mul_f32 v55, v48, v33
    v_cvt_pk_bf16_f32 v56, v54, v55
    v_lshlrev_b32 v54, 16, v56
    v_and_b32 v55, 0xffff0000, v56
    v_add_f32 v52, v52, v54
    v_add_f32 v53, v53, v55
    v_cvt_pk_bf16_f32 v56, v52, v53
    v_lshlrev_b32 v52, 16, v56
    v_and_b32 v53, 0xffff0000, v56
    v_mul_f32 v54, v41, v28
    v_mul_f32 v55, v49, v32
    v_cvt_pk_bf16_f32 v56, v54, v55
    v_lshlrev_b32 v54, 16, v56
    v_and_b32 v55, 0xffff0000, v56
    v_add_f32 v52, v52, v54
    v_add_f32 v53, v53, v55
    v_cvt_pk_bf16_f32 v56, v52, v53
    v_lshlrev_b32 v52, 16, v56
    v_and_b32 v53, 0xffff0000, v56
    v_lshlrev_b32 v54, 16, v19
    v_and_b32 v55, 0xffff0000, v19
    v_mul_f32 v52, v52, v54
    v_mul_f32 v53, v53, v55
    v_cvt_pk_bf16_f32 v62, v52, v53
    v_mul_f32 v54, v39, v31
    v_mul_f32 v55, v47, v35
    v_cvt_pk_bf16_f32 v56, v54, v55
    v_lshlrev_b32 v52, 16, v56
    v_and_b32 v53, 0xffff0000, v56
    v_mul_f32 v54, v40, v30
    v_mul_f32 v55, v48, v34
    v_cvt_pk_bf16_f32 v56, v54, v55
    v_lshlrev_b32 v54, 16, v56
    v_and_b32 v55, 0xffff0000, v56
    v_add_f32 v52, v52, v54
    v_add_f32 v53, v53, v55
    v_cvt_pk_bf16_f32 v56, v52, v53
    v_lshlrev_b32 v52, 16, v56
    v_and_b32 v53, 0xffff0000, v56
    v_mul_f32 v54, v41, v29
    v_mul_f32 v55, v49, v33
    v_cvt_pk_bf16_f32 v56, v54, v55
    v_lshlrev_b32 v54, 16, v56
    v_and_b32 v55, 0xffff0000, v56
    v_add_f32 v52, v52, v54
    v_add_f32 v53, v53, v55
    v_cvt_pk_bf16_f32 v56, v52, v53
    v_lshlrev_b32 v52, 16, v56
    v_and_b32 v53, 0xffff0000, v56
    v_mul_f32 v54, v42, v28
    v_mul_f32 v55, v50, v32
    v_cvt_pk_bf16_f32 v56, v54, v55
    v_lshlrev_b32 v54, 16, v56
    v_and_b32 v55, 0xffff0000, v56
    v_add_f32 v52, v52, v54
    v_add_f32 v53, v53, v55
    v_cvt_pk_bf16_f32 v56, v52, v53
    v_lshlrev_b32 v52, 16, v56
    v_and_b32 v53, 0xffff0000, v56
    v_lshlrev_b32 v54, 16, v20
    v_and_b32 v55, 0xffff0000, v20
    v_mul_f32 v52, v52, v54
    v_mul_f32 v53, v53, v55
    v_cvt_pk_bf16_f32 v63, v52, v53
    v_lshlrev_b32 v9, 13, v1
    v_lshl_add_u32 v9, v3, 2, v9
    buffer_store_dwordx4 v[60:63], v9, s[28:31], 0 offen
    s_endpgm
L_kv_kgen:
    s_cmp_ge_u32 s2, 768
    s_cbranch_scc1 L_kv_ln0
    s_sub_u32 s55, s2, 256
    s_load_dwordx8 s[4:11], s[0:1], 56
    s_load_dwordx2 s[12:13], s[0:1], 88
    s_load_dwordx2 s[14:15], s[0:1], 120
    v_and_b32 v1, 15, v0
    v_bfe_u32 v2, v0, 4, 2
    v_lshrrev_b32 v3, 6, v0
    s_lshl_b32 s3, s55, 8
    v_lshlrev_b32 v4, 5, v3
    v_lshl_add_u32 v4, v1, 1, v4
    s_mov_b32 s50, 0x3fb8aa3b
    s_mov_b32 s51, 0x32a57060
    s_mov_b32 s52, 0x3f317218
    s_mov_b32 s53, 0x3e22f983
    s_mov_b32 s54, 0x07060302
    v_readfirstlane_b32 s56, v3
    s_waitcnt lgkmcnt(0)
    s_mov_b32 s16, s4
    s_and_b32 s17, s5, 0xffff
    s_mov_b32 s18, 131072
    s_mov_b32 s19, 0x00020000
    s_mov_b32 s20, s6
    s_and_b32 s21, s7, 0xffff
    s_mov_b32 s22, 131072
    s_mov_b32 s23, 0x00020000
    s_mov_b32 s24, s8
    s_and_b32 s25, s9, 0xffff
    s_mov_b32 s26, 131072
    s_mov_b32 s27, 0x00020000
    s_mov_b32 s28, s10
    s_and_b32 s29, s11, 0xffff
    s_mov_b32 s30, 131072
    s_mov_b32 s31, 0x00020000
    s_mov_b32 s32, s14
    s_and_b32 s33, s15, 0xffff
    s_mov_b32 s34, 268435456
    s_mov_b32 s35, 0x00020000
    buffer_load_ushort v8, v4, s[16:19], s3 offen
    buffer_load_ushort v9, v4, s[20:23], s3 offen
    buffer_load_ushort v10, v4, s[24:27], s3 offen
    buffer_load_ushort v11, v4, s[28:31], s3 offen
    s_lshr_b32 s36, s55, 1
    s_lshl_b32 s36, s36, 2
    s_add_u32 s12, s12, s36
    s_addc_u32 s13, s13, 0
    s_load_dword s37, s[12:13], 0
    v_lshrrev_b32 v28, 3, v1
    v_lshlrev_b32 v28, 7, v28
    v_and_b32 v29, 7, v1
    v_or_b32 v24, v28, v29
    v_lshrrev_b32 v28, 2, v1
    v_lshlrev_b32 v28, 7, v28
    v_and_b32 v29, 3, v1
    v_lshl_add_u32 v28, v29, 1, v28
    v_add_u32 v28, 256, v28
    v_bfe_u32 v29, v1, 1, 2
    v_lshlrev_b32 v29, 7, v29
    v_and_b32 v30, 1, v1
    v_lshl_add_u32 v29, v30, 2, v29
    v_add_u32 v29, 512, v29
    v_cmp_gt_u32 vcc, 8, v1
    s_nop 1
    v_cndmask_b32 v25, v29, v28, vcc
    v_lshlrev_b32 v28, 7, v1
    v_add_u32 v28, 1024, v28
    v_min_u32 v26, 2048, v28
    v_lshlrev_b32 v27, 3, v1
    v_cvt_f32_u32 v24, v24
    v_cvt_f32_u32 v25, v25
    v_cvt_f32_u32 v26, v26
    v_cvt_f32_u32 v27, v27
    v_lshlrev_b32 v5, 8, v3
    v_lshl_add_u32 v6, v1, 4, v5
    v_lshl_add_u32 v5, v2, 6, v5
    s_waitcnt lgkmcnt(0)
    s_lshl_b32 s38, s37, 16
    s_and_b32 s39, s37, 0xffff0000
    s_bitcmp1_b32 s55, 0
    s_cselect_b32 s38, s39, s38
    v_mov_b32 v28, s38
    v_mul_f32 v30, s50, v28
    v_fma_f32 v31, v28, s50, -v30
    v_fmac_f32 v31, s51, v28
    v_exp_f32 v30, v30
    v_fma_f32 v31, v31, s52, 1.0
    v_mul_f32 v29, v30, v31
    v_cvt_pk_bf16_f32 v29, v29, v29
    v_and_b32 v29, 0xffff0000, v29
    s_waitcnt vmcnt(0)
    v_lshlrev_b32 v8, 16, v8
    v_lshlrev_b32 v9, 16, v9
    v_lshlrev_b32 v10, 16, v10
    v_lshlrev_b32 v11, 16, v11
    v_mul_f32 v30, s50, v8
    v_fma_f32 v31, v8, s50, -v30
    v_fmac_f32 v31, s51, v8
    v_exp_f32 v30, v30
    v_fma_f32 v31, v31, s52, 1.0
    v_mul_f32 v12, v30, v31
    v_cvt_pk_bf16_f32 v12, v12, v12
    v_and_b32 v12, 0xffff0000, v12
    v_mul_f32 v12, v12, v29
    v_mul_f32 v12, 0xbfb8aa3b, v12
    v_mul_f32 v13, v9, v29
    v_mul_f32 v13, s53, v13
    v_mul_f32 v14, v10, v29
    v_mul_f32 v15, v11, v29
    v_add_f32 v14, v14, v14
    v_add_f32 v15, v15, v15
    ds_write_b128 v6, v[12:15] offset:24576
    s_waitcnt lgkmcnt(0)
    s_waitcnt vmcnt(0)
    v_mov_b32 v7, 0x07060302
    ds_read_b128 v[8:11], v5 offset:24576
    ds_read_b128 v[12:15], v5 offset:24592
    s_waitcnt lgkmcnt(0)
    v_mul_f32 v17, v9, v24
    v_mul_f32 v20, v9, v25
    v_mul_f32 v23, v9, v26
    v_mul_f32 v30, v9, v27
    v_mul_f32 v33, v13, v24
    v_mul_f32 v36, v13, v25
    v_mul_f32 v39, v13, v26
    v_mul_f32 v42, v13, v27
    v_mul_f32 v16, v8, v24
    v_mul_f32 v19, v8, v25
    v_mul_f32 v22, v8, v26
    v_mul_f32 v29, v8, v27
    v_mul_f32 v32, v12, v24
    v_mul_f32 v35, v12, v25
    v_mul_f32 v38, v12, v26
    v_mul_f32 v41, v12, v27
    v_fract_f32 v17, v17
    v_fract_f32 v20, v20
    v_fract_f32 v23, v23
    v_fract_f32 v30, v30
    v_fract_f32 v33, v33
    v_fract_f32 v36, v36
    v_fract_f32 v39, v39
    v_fract_f32 v42, v42
    v_exp_f32 v16, v16
    v_exp_f32 v19, v19
    v_exp_f32 v22, v22
    v_exp_f32 v29, v29
    v_exp_f32 v32, v32
    v_exp_f32 v35, v35
    v_exp_f32 v38, v38
    v_exp_f32 v41, v41
    v_cos_f32 v18, v17
    v_cos_f32 v21, v20
    v_cos_f32 v28, v23
    v_cos_f32 v31, v30
    v_cos_f32 v34, v33
    v_cos_f32 v37, v36
    v_cos_f32 v40, v39
    v_cos_f32 v43, v42
    v_sin_f32 v17, v17
    v_sin_f32 v20, v20
    v_sin_f32 v23, v23
    v_sin_f32 v30, v30
    v_sin_f32 v33, v33
    v_sin_f32 v36, v36
    v_sin_f32 v39, v39
    v_sin_f32 v42, v42
    v_mul_f32 v18, v18, v16
    v_mul_f32 v17, v17, v16
    v_mul_f32 v21, v21, v19
    v_mul_f32 v20, v20, v19
    v_mul_f32 v28, v28, v22
    v_mul_f32 v23, v23, v22
    v_mul_f32 v34, v34, v32
    v_mul_f32 v33, v33, v32
    v_mul_f32 v37, v37, v35
    v_mul_f32 v36, v36, v35
    v_mul_f32 v40, v40, v38
    v_mul_f32 v39, v39, v38
    v_mul_f32 v44, v10, v29
    v_mul_f32 v29, v11, v29
    v_mul_f32 v46, v14, v41
    v_mul_f32 v41, v15, v41
    v_mul_f32 v45, v29, v30
    v_mul_f32 v29, v29, v31
    v_mul_f32 v47, v41, v42
    v_mul_f32 v41, v41, v43
    v_fma_f32 v31, v44, v31, -v45
    v_fma_f32 v30, -v44, v30, -v29
    v_fma_f32 v43, v46, v43, -v47
    v_fma_f32 v42, -v46, v42, -v41
    v_perm_b32 v48, v17, v18, v7
    v_perm_b32 v52, v20, v21, v7
    v_perm_b32 v56, v23, v28, v7
    v_perm_b32 v72, v30, v31, v7
    v_perm_b32 v49, v33, v34, v7
    v_perm_b32 v53, v36, v37, v7
    v_perm_b32 v57, v39, v40, v7
    v_perm_b32 v73, v42, v43, v7
    v_and_b32 v16, 0xffff0000, v18
    v_and_b32 v19, 0xffff0000, v21
    v_and_b32 v22, 0xffff0000, v28
    v_and_b32 v29, 0xffff0000, v31
    v_and_b32 v32, 0xffff0000, v34
    v_and_b32 v35, 0xffff0000, v37
    v_and_b32 v38, 0xffff0000, v40
    v_and_b32 v41, 0xffff0000, v43
    v_sub_f32 v18, v18, v16
    v_sub_f32 v21, v21, v19
    v_sub_f32 v28, v28, v22
    v_sub_f32 v31, v31, v29
    v_sub_f32 v34, v34, v32
    v_sub_f32 v37, v37, v35
    v_sub_f32 v40, v40, v38
    v_sub_f32 v43, v43, v41
    v_and_b32 v16, 0xffff0000, v17
    v_and_b32 v19, 0xffff0000, v20
    v_and_b32 v22, 0xffff0000, v23
    v_and_b32 v29, 0xffff0000, v30
    v_and_b32 v32, 0xffff0000, v33
    v_and_b32 v35, 0xffff0000, v36
    v_and_b32 v38, 0xffff0000, v39
    v_and_b32 v41, 0xffff0000, v42
    v_sub_f32 v17, v17, v16
    v_sub_f32 v20, v20, v19
    v_sub_f32 v23, v23, v22
    v_sub_f32 v30, v30, v29
    v_sub_f32 v33, v33, v32
    v_sub_f32 v36, v36, v35
    v_sub_f32 v39, v39, v38
    v_sub_f32 v42, v42, v41
    v_cvt_pk_bf16_f32 v60, v18, v17
    v_cvt_pk_bf16_f32 v64, v21, v20
    v_cvt_pk_bf16_f32 v68, v28, v23
    v_cvt_pk_bf16_f32 v76, v31, v30
    v_cvt_pk_bf16_f32 v61, v34, v33
    v_cvt_pk_bf16_f32 v65, v37, v36
    v_cvt_pk_bf16_f32 v69, v40, v39
    v_cvt_pk_bf16_f32 v77, v43, v42
    ds_read_b128 v[8:11], v5 offset:24608
    ds_read_b128 v[12:15], v5 offset:24624
    s_waitcnt lgkmcnt(0) vmcnt(0)
    v_mul_f32 v17, v9, v24
    v_mul_f32 v20, v9, v25
    v_mul_f32 v23, v9, v26
    v_mul_f32 v30, v9, v27
    v_mul_f32 v33, v13, v24
    v_mul_f32 v36, v13, v25
    v_mul_f32 v39, v13, v26
    v_mul_f32 v42, v13, v27
    v_mul_f32 v16, v8, v24
    v_mul_f32 v19, v8, v25
    v_mul_f32 v22, v8, v26
    v_mul_f32 v29, v8, v27
    v_mul_f32 v32, v12, v24
    v_mul_f32 v35, v12, v25
    v_mul_f32 v38, v12, v26
    v_mul_f32 v41, v12, v27
    v_fract_f32 v17, v17
    v_fract_f32 v20, v20
    v_fract_f32 v23, v23
    v_fract_f32 v30, v30
    v_fract_f32 v33, v33
    v_fract_f32 v36, v36
    v_fract_f32 v39, v39
    v_fract_f32 v42, v42
    v_exp_f32 v16, v16
    v_exp_f32 v19, v19
    v_exp_f32 v22, v22
    v_exp_f32 v29, v29
    v_exp_f32 v32, v32
    v_exp_f32 v35, v35
    v_exp_f32 v38, v38
    v_exp_f32 v41, v41
    v_cos_f32 v18, v17
    v_cos_f32 v21, v20
    v_cos_f32 v28, v23
    v_cos_f32 v31, v30
    v_cos_f32 v34, v33
    v_cos_f32 v37, v36
    v_cos_f32 v40, v39
    v_cos_f32 v43, v42
    v_sin_f32 v17, v17
    v_sin_f32 v20, v20
    v_sin_f32 v23, v23
    v_sin_f32 v30, v30
    v_sin_f32 v33, v33
    v_sin_f32 v36, v36
    v_sin_f32 v39, v39
    v_sin_f32 v42, v42
    v_mul_f32 v18, v18, v16
    v_mul_f32 v17, v17, v16
    v_mul_f32 v21, v21, v19
    v_mul_f32 v20, v20, v19
    v_mul_f32 v28, v28, v22
    v_mul_f32 v23, v23, v22
    v_mul_f32 v34, v34, v32
    v_mul_f32 v33, v33, v32
    v_mul_f32 v37, v37, v35
    v_mul_f32 v36, v36, v35
    v_mul_f32 v40, v40, v38
    v_mul_f32 v39, v39, v38
    v_mul_f32 v44, v10, v29
    v_mul_f32 v29, v11, v29
    v_mul_f32 v46, v14, v41
    v_mul_f32 v41, v15, v41
    v_mul_f32 v45, v29, v30
    v_mul_f32 v29, v29, v31
    v_mul_f32 v47, v41, v42
    v_mul_f32 v41, v41, v43
    v_fma_f32 v31, v44, v31, -v45
    v_fma_f32 v30, -v44, v30, -v29
    v_fma_f32 v43, v46, v43, -v47
    v_fma_f32 v42, -v46, v42, -v41
    v_perm_b32 v50, v17, v18, v7
    v_perm_b32 v54, v20, v21, v7
    v_perm_b32 v58, v23, v28, v7
    v_perm_b32 v74, v30, v31, v7
    v_perm_b32 v51, v33, v34, v7
    v_perm_b32 v55, v36, v37, v7
    v_perm_b32 v59, v39, v40, v7
    v_perm_b32 v75, v42, v43, v7
    v_and_b32 v16, 0xffff0000, v18
    v_and_b32 v19, 0xffff0000, v21
    v_and_b32 v22, 0xffff0000, v28
    v_and_b32 v29, 0xffff0000, v31
    v_and_b32 v32, 0xffff0000, v34
    v_and_b32 v35, 0xffff0000, v37
    v_and_b32 v38, 0xffff0000, v40
    v_and_b32 v41, 0xffff0000, v43
    v_sub_f32 v18, v18, v16
    v_sub_f32 v21, v21, v19
    v_sub_f32 v28, v28, v22
    v_sub_f32 v31, v31, v29
    v_sub_f32 v34, v34, v32
    v_sub_f32 v37, v37, v35
    v_sub_f32 v40, v40, v38
    v_sub_f32 v43, v43, v41
    v_and_b32 v16, 0xffff0000, v17
    v_and_b32 v19, 0xffff0000, v20
    v_and_b32 v22, 0xffff0000, v23
    v_and_b32 v29, 0xffff0000, v30
    v_and_b32 v32, 0xffff0000, v33
    v_and_b32 v35, 0xffff0000, v36
    v_and_b32 v38, 0xffff0000, v39
    v_and_b32 v41, 0xffff0000, v42
    v_sub_f32 v17, v17, v16
    v_sub_f32 v20, v20, v19
    v_sub_f32 v23, v23, v22
    v_sub_f32 v30, v30, v29
    v_sub_f32 v33, v33, v32
    v_sub_f32 v36, v36, v35
    v_sub_f32 v39, v39, v38
    v_sub_f32 v42, v42, v41
    v_cvt_pk_bf16_f32 v62, v18, v17
    v_cvt_pk_bf16_f32 v66, v21, v20
    v_cvt_pk_bf16_f32 v70, v28, v23
    v_cvt_pk_bf16_f32 v78, v31, v30
    v_cvt_pk_bf16_f32 v63, v34, v33
    v_cvt_pk_bf16_f32 v67, v37, v36
    v_cvt_pk_bf16_f32 v71, v40, v39
    v_cvt_pk_bf16_f32 v79, v43, v42
    v_mfma_f32_16x16x32_bf16 v[32:35], v[60:63], v[72:75], 0
    s_nop 0
    v_mfma_f32_16x16x32_bf16 v[32:35], v[48:51], v[76:79], v[32:35]
    v_mfma_f32_16x16x32_bf16 v[32:35], v[48:51], v[72:75], v[32:35]
    v_mfma_f32_16x16x32_bf16 v[36:39], v[64:67], v[72:75], 0
    v_mfma_f32_16x16x32_bf16 v[36:39], v[52:55], v[76:79], v[36:39]
    v_mfma_f32_16x16x32_bf16 v[36:39], v[52:55], v[72:75], v[36:39]
    v_mfma_f32_16x16x32_bf16 v[40:43], v[68:71], v[72:75], 0
    v_mfma_f32_16x16x32_bf16 v[40:43], v[56:59], v[76:79], v[40:43]
    v_mfma_f32_16x16x32_bf16 v[40:43], v[56:59], v[72:75], v[40:43]
    v_and_b32 v30, 63, v0
    v_lshlrev_b32 v30, 4, v30
    v_mul_u32_u24 v31, 3072, v3
    v_add_u32 v31, v31, v30
    v_and_b32 v7, 3, v0
    v_lshrrev_b32 v5, 2, v0
    v_lshl_add_u32 v4, v5, 3, v7
    v_add_u32 v8, 0, v4
    v_add_u32 v9, 4, v4
    v_add_u32 v10, 1024, v4
    v_add_u32 v11, 1028, v4
    v_cvt_f32_u32 v8, v8
    v_cvt_f32_u32 v9, v9
    v_cvt_f32_u32 v10, v10
    v_cvt_f32_u32 v11, v11
    v_cvt_pk_bf16_f32 v17, v8, v9
    v_lshlrev_b32 v8, 16, v17
    v_and_b32 v9, 0xffff0000, v17
    v_cvt_pk_bf16_f32 v17, v10, v11
    v_lshlrev_b32 v10, 16, v17
    v_and_b32 v11, 0xffff0000, v17
    v_cvt_u32_f32 v8, v8
    v_lshlrev_b32 v8, 2, v8
    v_cvt_u32_f32 v9, v9
    v_lshlrev_b32 v9, 2, v9
    v_cvt_u32_f32 v10, v10
    v_lshlrev_b32 v10, 2, v10
    v_cvt_u32_f32 v11, v11
    v_lshlrev_b32 v11, 2, v11
    s_lshl_b32 s42, s55, 12
    s_add_u32 s42, s42, 12582912
    v_lshlrev_b32 v4, 10, v7
    v_lshl_add_u32 v4, v5, 2, v4
    ds_write_b128 v31, v[32:35] offset:0
    ds_write_b128 v31, v[36:39] offset:1024
    ds_write_b128 v31, v[40:43] offset:2048
    s_waitcnt lgkmcnt(0)
    s_barrier
    s_cmp_ge_u32 s56, 3
    s_cbranch_scc1 L_kg2_skip
    s_lshl_b32 s57, s56, 10
    v_add_u32 v30, s57, v30
    ds_read_b128 v[32:35], v30 offset:0
    ds_read_b128 v[36:39], v30 offset:3072
    ds_read_b128 v[40:43], v30 offset:6144
    ds_read_b128 v[44:47], v30 offset:9216
    ds_read_b128 v[48:51], v30 offset:12288
    ds_read_b128 v[52:55], v30 offset:15360
    ds_read_b128 v[56:59], v30 offset:18432
    ds_read_b128 v[60:63], v30 offset:21504
    v_lshlrev_b32 v65, 5, v1
    s_waitcnt lgkmcnt(0)
    v_add_f32 v32, v32, v36
    v_add_f32 v40, v40, v44
    v_add_f32 v48, v48, v52
    v_add_f32 v56, v56, v60
    v_add_f32 v32, v32, v40
    v_add_f32 v48, v48, v56
    v_add_f32 v32, v32, v48
    v_add_f32 v33, v33, v37
    v_add_f32 v41, v41, v45
    v_add_f32 v49, v49, v53
    v_add_f32 v57, v57, v61
    v_add_f32 v33, v33, v41
    v_add_f32 v49, v49, v57
    v_add_f32 v33, v33, v49
    v_add_f32 v34, v34, v38
    v_add_f32 v42, v42, v46
    v_add_f32 v50, v50, v54
    v_add_f32 v58, v58, v62
    v_add_f32 v34, v34, v42
    v_add_f32 v50, v50, v58
    v_add_f32 v34, v34, v50
    v_add_f32 v35, v35, v39
    v_add_f32 v43, v43, v47
    v_add_f32 v51, v51, v55
    v_add_f32 v59, v59, v63
    v_add_f32 v35, v35, v43
    v_add_f32 v51, v51, v59
    v_add_f32 v35, v35, v51
    s_cmp_eq_u32 s56, 1
    s_cbranch_scc1 L_kg2_t1
    s_cmp_eq_u32 s56, 2
    s_cbranch_scc1 L_kg2_t2
    v_lshrrev_b32 v64, 1, v2
    v_lshlrev_b32 v64, 9, v64
    v_and_b32 v66, 1, v2
    v_lshl_add_u32 v64, v66, 4, v64
    v_add_u32 v64, v65, v64
    ds_write_b128 v64, v[32:35] offset:26624
    s_branch L_kg2_skip
L_kg2_t1:
    v_lshlrev_b32 v64, 9, v2
    v_add_u32 v64, 1024, v64
    v_lshlrev_b32 v66, 10, v2
    v_cmp_gt_u32 vcc, 2, v2
    s_nop 1
    v_cndmask_b32 v64, v66, v64, vcc
    v_add_u32 v64, v65, v64
    ds_write_b32 v64, v32 offset:26624
    v_mov_b32 v67, 16
    v_cndmask_b32 v66, v67, 8, vcc
    v_add_u32 v66, v64, v66
    ds_write_b32 v66, v33 offset:26624
    v_mov_b32 v67, 512
    v_cndmask_b32 v66, v67, 16, vcc
    v_add_u32 v66, v64, v66
    ds_write_b32 v66, v34 offset:26624
    v_mov_b32 v67, 528
    v_cndmask_b32 v66, v67, 24, vcc
    v_add_u32 v66, v64, v66
    ds_write_b32 v66, v35 offset:26624
    s_branch L_kg2_skip
L_kg2_t2:
    v_lshlrev_b32 v64, 11, v2
    v_add_u32 v64, v65, v64
    v_cmp_gt_u32 vcc, 3, v2
    s_nop 0
    s_and_saveexec_b64 s[40:41], vcc
    ds_write_b32 v64, v32 offset:30720
    s_mov_b64 exec, s[40:41]
    v_cmp_gt_u32 vcc, 2, v2
    s_nop 0
    s_and_saveexec_b64 s[40:41], vcc
    ds_write_b32 v64, v33 offset:31232
    ds_write_b32 v64, v34 offset:31744
    ds_write_b32 v64, v35 offset:32256
    s_mov_b64 exec, s[40:41]
L_kg2_skip:
    s_waitcnt lgkmcnt(0)
    s_barrier
    ds_read_b32 v20, v8 offset:26624
    ds_read_b32 v21, v9 offset:26624
    ds_read_b32 v22, v10 offset:26624
    ds_read_b32 v23, v11 offset:26624
    s_waitcnt lgkmcnt(0)
    v_cvt_pk_bf16_f32 v16, v20, v21
    buffer_store_dword v16, v4, s[32:35], s42 offen offset:0
    v_cvt_pk_bf16_f32 v17, v22, v23
    buffer_store_dword v17, v4, s[32:35], s42 offen offset:512
    s_endpgm
L_kv_ln0:
L_kv_end:
    s_endpgm

.globl convA_kernel
.p2align 8
.type convA_kernel,@function
convA_kernel:
    s_cmp_ge_u32 s2, 256
    s_cbranch_scc1 L_convA_kernel_end
    s_load_dwordx2 s[10:11], s[0:1], 120
    s_load_dwordx4 s[4:7], s[0:1], 32
    s_and_b32 s3, s2, 7
    s_lshl_b32 s3, s3, 5
    s_lshr_b32 s12, s2, 3
    s_add_u32 s3, s3, s12
    v_lshrrev_b32 v1, 6, v0
    v_and_b32 v2, 63, v0
    v_lshlrev_b32 v14, 4, v0
    v_readfirstlane_b32 s14, v1
    s_lshl_b32 s13, s3, 13
    s_lshl_b32 s15, s3, 2
    s_waitcnt lgkmcnt(0)
    s_mov_b32 s28, s10
    s_and_b32 s29, s11, 0xffff
    s_mov_b32 s30, 268435456
    s_mov_b32 s31, 0x00020000
    s_add_u32 s32, s13, 0
    buffer_load_dwordx4 v[4:7], v14, s[28:31], s32 offen
    s_mov_b32 s16, s4
    s_and_b32 s17, s5, 0xffff
    s_mov_b32 s18, 2097152
    s_mov_b32 s19, 0x00020000
    buffer_load_dwordx4 v[48:51], v14, s[16:19], s13 offen
    s_add_u32 s6, s6, s15
    s_addc_u32 s7, s7, 0
    s_load_dword s33, s[6:7], 0
    v_mov_b32 v64, 0
    v_mov_b32 v65, 0
    v_mov_b32 v66, 0
    v_mov_b32 v67, 0
    v_lshrrev_b32 v61, 4, v0
    v_mul_u32_u24 v61, 1152, v61
    v_and_b32 v62, 15, v0
    v_lshl_add_u32 v61, v62, 3, v61
    v_cmp_gt_u32 vcc, 128, v0
    s_nop 0
    s_and_saveexec_b64 s[36:37], vcc
    ds_write_b64 v61, v[64:65] offset:8320
    ds_write_b64 v61, v[64:65] offset:17672
    s_mov_b64 exec, s[36:37]
    v_lshrrev_b32 v61, 1, v0
    v_mul_u32_u24 v61, 4160, v61
    v_and_b32 v62, 1, v0
    v_lshl_add_u32 v61, v62, 4, v61
    v_cmp_gt_u32 vcc, 4, v0
    s_nop 0
    s_and_saveexec_b64 s[36:37], vcc
    ds_write_b128 v61, v[64:67] offset:0
    s_mov_b64 exec, s[36:37]
    s_mov_b32 s38, 0x05040100
    s_mov_b32 s39, 0x07060302
    s_lshr_b32 s40, s14, 2
    s_and_b32 s41, s14, 3
    s_mul_i32 s42, s40, 4160
    s_add_u32 s42, s42, 32
    s_mul_i32 s43, s40, 4
    s_add_u32 s43, s43, s41
    s_mul_i32 s43, s43, 1152
    s_add_u32 s43, s43, 8376
    v_lshrrev_b32 v70, 4, v2
    v_and_b32 v71, 3, v2
    v_bfe_u32 v72, v2, 2, 2
    v_sub_u32 v71, v71, v72
    v_lshlrev_b32 v71, 3, v71
    v_lshl_add_u32 v71, v70, 6, v71
    v_add_u32 v12, s42, v71
    v_and_b32 v71, 15, v2
    v_lshlrev_b32 v71, 3, v71
    v_lshlrev_b32 v72, 4, v70
    v_sub_u32 v71, v71, v72
    v_add_u32 v13, s43, v71
    v_and_b32 v71, 1, v2
    v_xor_b32 v71, 1, v71
    v_mul_u32_u24 v71, 9352, v71
    v_add_u32 v13, v13, v71
    v_mov_b32 v16, 0
    v_mov_b32 v17, 0
    v_mov_b32 v18, 0
    v_mov_b32 v19, 0
    v_mov_b32 v20, 0
    v_mov_b32 v21, 0
    v_mov_b32 v22, 0
    v_mov_b32 v23, 0
    v_mov_b32 v24, 0
    v_mov_b32 v25, 0
    v_mov_b32 v26, 0
    v_mov_b32 v27, 0
    v_mov_b32 v28, 0
    v_mov_b32 v29, 0
    v_mov_b32 v30, 0
    v_mov_b32 v31, 0
    v_mov_b32 v32, 0
    v_mov_b32 v33, 0
    v_mov_b32 v34, 0
    v_mov_b32 v35, 0
    v_mov_b32 v36, 0
    v_mov_b32 v37, 0
    v_mov_b32 v38, 0
    v_mov_b32 v39, 0
    v_mov_b32 v40, 0
    v_mov_b32 v41, 0
    v_mov_b32 v42, 0
    v_mov_b32 v43, 0
    v_mov_b32 v44, 0
    v_mov_b32 v45, 0
    v_mov_b32 v46, 0
    v_mov_b32 v47, 0
    v_and_b32 v70, 15, v2
    v_lshrrev_b32 v71, 4, v2
    v_lshlrev_b32 v72, 2, v71
    v_xor_b32 v70, v70, v72
    v_lshl_add_u32 v70, v71, 4, v70
    v_lshlrev_b32 v70, 4, v70
    s_mul_i32 s44, s14, 8208
    s_add_u32 s44, s44, 27136
    v_add_u32 v176, s44, v70
    v_mov_b32 v70, s44
    s_mov_b64 exec, 1
    ds_write_b128 v70, v[64:67] offset:8192
    s_mov_b64 exec, -1
    v_lshrrev_b32 v70, 2, v2
    v_and_b32 v71, 3, v2
    v_lshlrev_b32 v72, 2, v71
    v_xor_b32 v70, v70, v72
    v_lshl_add_u32 v70, v71, 4, v70
    v_lshlrev_b32 v70, 4, v70
    s_lshl_b32 s44, s14, 10
    s_add_u32 s44, s44, 27136
    v_add_u32 v177, s44, v70
    v_subrev_u32 v73, 1, v2
    v_lshrrev_b32 v71, 2, v73
    v_and_b32 v73, 3, v73
    v_lshlrev_b32 v72, 2, v73
    v_xor_b32 v71, v71, v72
    v_lshl_add_u32 v71, v73, 4, v71
    v_lshlrev_b32 v71, 4, v71
    v_add_u32 v71, s44, v71
    s_sub_u32 s45, s44, 208
    s_cmp_eq_u32 s14, 0
    s_cselect_b32 s45, 35328, s45
    v_mov_b32 v72, s45
    v_cmp_eq_u32 vcc, 0, v2
    s_nop 1
    v_cndmask_b32 v178, v71, v72, vcc
    v_add_u32 v179, 32832, v177
    v_add_u32 v180, 32832, v178
    v_lshlrev_b32 v62, 3, v0
    v_lshrrev_b32 v61, 8, v0
    v_mul_u32_u24 v61, 4608, v61
    v_and_b32 v63, 255, v0
    v_lshl_add_u32 v61, v63, 2, v61
    s_waitcnt vmcnt(1)
    v_perm_b32 v64, v5, v4, s38
    v_perm_b32 v65, v7, v6, s38
    v_perm_b32 v66, v5, v4, s39
    v_perm_b32 v67, v7, v6, s39
    ds_write_b64 v62, v[64:65] offset:32
    ds_write_b64 v62, v[66:67] offset:4192
    s_waitcnt vmcnt(0)
    v_perm_b32 v68, v50, v48, s38
    v_perm_b32 v69, v50, v48, s39
    v_perm_b32 v70, v51, v49, s38
    v_perm_b32 v71, v51, v49, s39
    ds_write_b32 v61, v68 offset:8448
    ds_write_b32 v61, v68 offset:17800
    ds_write_b32 v61, v69 offset:9600
    ds_write_b32 v61, v69 offset:18952
    ds_write_b32 v61, v70 offset:10752
    ds_write_b32 v61, v70 offset:20104
    ds_write_b32 v61, v71 offset:11904
    ds_write_b32 v61, v71 offset:21256
    s_waitcnt lgkmcnt(0)
    s_lshl_b32 s46, s33, 16
    s_and_b32 s47, s33, 0xffff0000
    s_barrier
    ds_read_b64_tr_b16 v[48:49], v12 offset:32
    ds_read_b64_tr_b16 v[50:51], v12 offset:0
    ds_read_b128 v[80:83], v13 offset:64
    ds_read_b128 v[84:87], v13 offset:192
    ds_read_b64_tr_b16 v[52:53], v12 offset:544
    ds_read_b64_tr_b16 v[54:55], v12 offset:512
    ds_read_b128 v[88:91], v13 offset:320
    ds_read_b64_tr_b16 v[56:57], v12 offset:1056
    ds_read_b64_tr_b16 v[58:59], v12 offset:1024
    ds_read_b128 v[92:95], v13 offset:448
    ds_read_b64_tr_b16 v[60:61], v12 offset:1568
    ds_read_b64_tr_b16 v[62:63], v12 offset:1536
    ds_read_b128 v[96:99], v13 offset:576
    ds_read_b64_tr_b16 v[64:65], v12 offset:2080
    ds_read_b64_tr_b16 v[66:67], v12 offset:2048
    ds_read_b128 v[100:103], v13 offset:704
    ds_read_b64_tr_b16 v[68:69], v12 offset:2592
    ds_read_b64_tr_b16 v[70:71], v12 offset:2560
    ds_read_b128 v[104:107], v13 offset:832
    ds_read_b64_tr_b16 v[72:73], v12 offset:3104
    ds_read_b64_tr_b16 v[74:75], v12 offset:3072
    ds_read_b128 v[108:111], v13 offset:960
    ds_read_b64_tr_b16 v[76:77], v12 offset:3616
    ds_read_b64_tr_b16 v[78:79], v12 offset:3584
    s_waitcnt lgkmcnt(15)
    v_mfma_f32_16x16x32_bf16 v[16:19], v[48:51], v[80:83], v[16:19]
    ds_read_b64_tr_b16 v[112:113], v12 offset:288
    v_mfma_f32_16x16x32_bf16 v[20:23], v[48:51], v[84:87], v[20:23]
    ds_read_b64_tr_b16 v[114:115], v12 offset:256
    v_mfma_f32_16x16x32_bf16 v[20:23], v[52:55], v[80:83], v[20:23]
    ds_read_b128 v[144:147], v13 offset:0
    v_mfma_f32_16x16x32_bf16 v[24:27], v[48:51], v[88:91], v[24:27]
    ds_read_b128 v[148:151], v13 offset:128
    v_mfma_f32_16x16x32_bf16 v[24:27], v[52:55], v[84:87], v[24:27]
    ds_read_b64_tr_b16 v[116:117], v12 offset:800
    v_mfma_f32_16x16x32_bf16 v[24:27], v[56:59], v[80:83], v[24:27]
    ds_read_b64_tr_b16 v[118:119], v12 offset:768
    s_waitcnt lgkmcnt(15)
    v_mfma_f32_16x16x32_bf16 v[28:31], v[48:51], v[92:95], v[28:31]
    ds_read_b128 v[152:155], v13 offset:256
    v_mfma_f32_16x16x32_bf16 v[28:31], v[52:55], v[88:91], v[28:31]
    ds_read_b64_tr_b16 v[120:121], v12 offset:1312
    v_mfma_f32_16x16x32_bf16 v[28:31], v[56:59], v[84:87], v[28:31]
    ds_read_b64_tr_b16 v[122:123], v12 offset:1280
    v_mfma_f32_16x16x32_bf16 v[28:31], v[60:63], v[80:83], v[28:31]
    ds_read_b128 v[156:159], v13 offset:384
    v_mfma_f32_16x16x32_bf16 v[32:35], v[48:51], v[96:99], v[32:35]
    ds_read_b64_tr_b16 v[124:125], v12 offset:1824
    v_mfma_f32_16x16x32_bf16 v[32:35], v[52:55], v[92:95], v[32:35]
    ds_read_b64_tr_b16 v[126:127], v12 offset:1792
    v_mfma_f32_16x16x32_bf16 v[32:35], v[56:59], v[88:91], v[32:35]
    ds_read_b128 v[160:163], v13 offset:512
    v_mfma_f32_16x16x32_bf16 v[32:35], v[60:63], v[84:87], v[32:35]
    ds_read_b64_tr_b16 v[128:129], v12 offset:2336
    v_mfma_f32_16x16x32_bf16 v[32:35], v[64:67], v[80:83], v[32:35]
    ds_read_b64_tr_b16 v[130:131], v12 offset:2304
    s_waitcnt lgkmcnt(15)
    v_mfma_f32_16x16x32_bf16 v[36:39], v[48:51], v[100:103], v[36:39]
    ds_read_b128 v[164:167], v13 offset:640
    v_mfma_f32_16x16x32_bf16 v[36:39], v[52:55], v[96:99], v[36:39]
    ds_read_b64_tr_b16 v[132:133], v12 offset:2848
    v_mfma_f32_16x16x32_bf16 v[36:39], v[56:59], v[92:95], v[36:39]
    ds_read_b64_tr_b16 v[134:135], v12 offset:2816
    v_mfma_f32_16x16x32_bf16 v[36:39], v[60:63], v[88:91], v[36:39]
    ds_read_b128 v[168:171], v13 offset:768
    v_mfma_f32_16x16x32_bf16 v[36:39], v[64:67], v[84:87], v[36:39]
    ds_read_b64_tr_b16 v[136:137], v12 offset:3360
    v_mfma_f32_16x16x32_bf16 v[36:39], v[68:71], v[80:83], v[36:39]
    ds_read_b64_tr_b16 v[138:139], v12 offset:3328
    v_mfma_f32_16x16x32_bf16 v[40:43], v[48:51], v[104:107], v[40:43]
    ds_read_b128 v[172:175], v13 offset:896
    v_mfma_f32_16x16x32_bf16 v[40:43], v[52:55], v[100:103], v[40:43]
    ds_read_b64_tr_b16 v[140:141], v12 offset:3872
    v_mfma_f32_16x16x32_bf16 v[40:43], v[56:59], v[96:99], v[40:43]
    ds_read_b64_tr_b16 v[142:143], v12 offset:3840
    v_mfma_f32_16x16x32_bf16 v[40:43], v[60:63], v[92:95], v[40:43]
    v_lshlrev_b32 v184, 16, v4
    v_mfma_f32_16x16x32_bf16 v[40:43], v[64:67], v[88:91], v[40:43]
    v_and_b32 v185, 0xffff0000, v4
    v_mfma_f32_16x16x32_bf16 v[40:43], v[68:71], v[84:87], v[40:43]
    v_mul_f32 v184, s46, v184
    v_mfma_f32_16x16x32_bf16 v[40:43], v[72:75], v[80:83], v[40:43]
    v_mul_f32 v185, s47, v185
    v_mfma_f32_16x16x32_bf16 v[44:47], v[48:51], v[108:111], v[44:47]
    v_cvt_pk_bf16_f32 v15, v184, v185
    v_mfma_f32_16x16x32_bf16 v[44:47], v[52:55], v[104:107], v[44:47]
    v_lshlrev_b32 v184, 16, v15
    v_mfma_f32_16x16x32_bf16 v[44:47], v[56:59], v[100:103], v[44:47]
    v_and_b32 v185, 0xffff0000, v15
    v_mfma_f32_16x16x32_bf16 v[44:47], v[60:63], v[96:99], v[44:47]
    v_lshlrev_b32 v186, 16, v5
    v_mfma_f32_16x16x32_bf16 v[44:47], v[64:67], v[92:95], v[44:47]
    v_and_b32 v187, 0xffff0000, v5
    v_mfma_f32_16x16x32_bf16 v[44:47], v[68:71], v[88:91], v[44:47]
    v_mul_f32 v186, s46, v186
    v_mfma_f32_16x16x32_bf16 v[44:47], v[72:75], v[84:87], v[44:47]
    v_mul_f32 v187, s47, v187
    v_mfma_f32_16x16x32_bf16 v[44:47], v[76:79], v[80:83], v[44:47]
    v_cvt_pk_bf16_f32 v15, v186, v187
    s_waitcnt lgkmcnt(15)
    v_mfma_f32_16x16x32_bf16 v[16:19], v[112:115], v[144:147], v[16:19]
    v_lshlrev_b32 v186, 16, v15
    v_mfma_f32_16x16x32_bf16 v[20:23], v[112:115], v[148:151], v[20:23]
    v_and_b32 v187, 0xffff0000, v15
    v_mfma_f32_16x16x32_bf16 v[20:23], v[116:119], v[144:147], v[20:23]
    v_lshlrev_b32 v188, 16, v6
    v_mfma_f32_16x16x32_bf16 v[24:27], v[112:115], v[152:155], v[24:27]
    v_and_b32 v189, 0xffff0000, v6
    v_mfma_f32_16x16x32_bf16 v[24:27], v[116:119], v[148:151], v[24:27]
    v_mul_f32 v188, s46, v188
    v_mfma_f32_16x16x32_bf16 v[24:27], v[120:123], v[144:147], v[24:27]
    v_mul_f32 v189, s47, v189
    ds_write_b128 v176, v[16:19] offset:0
    s_waitcnt lgkmcnt(15)
    v_mfma_f32_16x16x32_bf16 v[28:31], v[112:115], v[156:159], v[28:31]
    v_cvt_pk_bf16_f32 v15, v188, v189
    v_mfma_f32_16x16x32_bf16 v[28:31], v[116:119], v[152:155], v[28:31]
    v_lshlrev_b32 v188, 16, v15
    ds_write_b128 v176, v[20:23] offset:1024
    v_mfma_f32_16x16x32_bf16 v[28:31], v[120:123], v[148:151], v[28:31]
    v_and_b32 v189, 0xffff0000, v15
    s_waitcnt lgkmcnt(14)
    v_mfma_f32_16x16x32_bf16 v[28:31], v[124:127], v[144:147], v[28:31]
    v_lshlrev_b32 v190, 16, v7
    s_waitcnt lgkmcnt(13)
    v_mfma_f32_16x16x32_bf16 v[32:35], v[112:115], v[160:163], v[32:35]
    v_and_b32 v191, 0xffff0000, v7
    ds_write_b128 v176, v[24:27] offset:2048
    v_mfma_f32_16x16x32_bf16 v[32:35], v[116:119], v[156:159], v[32:35]
    v_mul_f32 v190, s46, v190
    v_mfma_f32_16x16x32_bf16 v[32:35], v[120:123], v[152:155], v[32:35]
    v_mul_f32 v191, s47, v191
    v_mfma_f32_16x16x32_bf16 v[32:35], v[124:127], v[148:151], v[32:35]
    v_cvt_pk_bf16_f32 v15, v190, v191
    s_waitcnt lgkmcnt(12)
    v_mfma_f32_16x16x32_bf16 v[32:35], v[128:131], v[144:147], v[32:35]
    v_lshlrev_b32 v190, 16, v15
    ds_write_b128 v176, v[28:31] offset:3072
    s_waitcnt lgkmcnt(12)
    v_mfma_f32_16x16x32_bf16 v[36:39], v[112:115], v[164:167], v[36:39]
    v_and_b32 v191, 0xffff0000, v15
    v_mfma_f32_16x16x32_bf16 v[36:39], v[116:119], v[160:163], v[36:39]
    v_mfma_f32_16x16x32_bf16 v[36:39], v[120:123], v[156:159], v[36:39]
    v_mfma_f32_16x16x32_bf16 v[36:39], v[124:127], v[152:155], v[36:39]
    v_mfma_f32_16x16x32_bf16 v[36:39], v[128:131], v[148:151], v[36:39]
    ds_write_b128 v176, v[32:35] offset:4096
    s_waitcnt lgkmcnt(11)
    v_mfma_f32_16x16x32_bf16 v[36:39], v[132:135], v[144:147], v[36:39]
    s_waitcnt lgkmcnt(10)
    v_mfma_f32_16x16x32_bf16 v[40:43], v[112:115], v[168:171], v[40:43]
    v_mfma_f32_16x16x32_bf16 v[40:43], v[116:119], v[164:167], v[40:43]
    v_mfma_f32_16x16x32_bf16 v[40:43], v[120:123], v[160:163], v[40:43]
    v_mfma_f32_16x16x32_bf16 v[40:43], v[124:127], v[156:159], v[40:43]
    v_mfma_f32_16x16x32_bf16 v[40:43], v[128:131], v[152:155], v[40:43]
    s_nop 1
    ds_write_b128 v176, v[36:39] offset:5120
    v_mfma_f32_16x16x32_bf16 v[40:43], v[132:135], v[148:151], v[40:43]
    s_waitcnt lgkmcnt(9)
    v_mfma_f32_16x16x32_bf16 v[40:43], v[136:139], v[144:147], v[40:43]
    s_waitcnt lgkmcnt(8)
    v_mfma_f32_16x16x32_bf16 v[44:47], v[112:115], v[172:175], v[44:47]
    v_mfma_f32_16x16x32_bf16 v[44:47], v[116:119], v[168:171], v[44:47]
    v_mfma_f32_16x16x32_bf16 v[44:47], v[120:123], v[164:167], v[44:47]
    v_mfma_f32_16x16x32_bf16 v[44:47], v[124:127], v[160:163], v[44:47]
    v_mfma_f32_16x16x32_bf16 v[44:47], v[128:131], v[156:159], v[44:47]
    s_nop 1
    ds_write_b128 v176, v[40:43] offset:6144
    v_mfma_f32_16x16x32_bf16 v[44:47], v[132:135], v[152:155], v[44:47]
    v_mfma_f32_16x16x32_bf16 v[44:47], v[136:139], v[148:151], v[44:47]
    s_waitcnt lgkmcnt(7)
    v_mfma_f32_16x16x32_bf16 v[44:47], v[140:143], v[144:147], v[44:47]
    s_nop 7
    ds_write_b128 v176, v[44:47] offset:7168
    s_waitcnt lgkmcnt(0)
    s_barrier
    ds_read_b128 v[48:51], v177 offset:0
    ds_read_b128 v[52:55], v177 offset:8208
    ds_read_b128 v[84:87], v178 offset:8208
    ds_read_b128 v[56:59], v177 offset:16416
    ds_read_b128 v[88:91], v178 offset:16416
    ds_read_b128 v[60:63], v177 offset:24624
    ds_read_b128 v[92:95], v178 offset:24624
    ds_read_b128 v[64:67], v179 offset:0
    ds_read_b128 v[68:71], v179 offset:8208
    ds_read_b128 v[100:103], v180 offset:8208
    ds_read_b128 v[72:75], v179 offset:16416
    ds_read_b128 v[104:107], v180 offset:16416
    ds_read_b128 v[76:79], v179 offset:24624
    ds_read_b128 v[108:111], v180 offset:24624
    s_waitcnt lgkmcnt(7)
    v_add_f32 v16, v48, v87
    v_add_f32 v24, v90, v93
    v_add_f32 v16, v16, v24
    v_add_f32 v17, v49, v52
    v_add_f32 v25, v91, v94
    v_add_f32 v17, v17, v25
    v_add_f32 v18, v50, v53
    v_add_f32 v26, v56, v95
    v_add_f32 v18, v18, v26
    v_add_f32 v19, v51, v54
    v_add_f32 v27, v57, v60
    v_add_f32 v19, v19, v27
    s_waitcnt lgkmcnt(0)
    v_add_f32 v20, v64, v103
    v_add_f32 v24, v106, v109
    v_add_f32 v20, v20, v24
    v_add_f32 v21, v65, v68
    v_add_f32 v25, v107, v110
    v_add_f32 v21, v21, v25
    v_add_f32 v22, v66, v69
    v_add_f32 v26, v72, v111
    v_add_f32 v22, v22, v26
    v_add_f32 v23, v67, v70
    v_add_f32 v27, v73, v76
    v_add_f32 v23, v23, v27
    v_cvt_pk_bf16_f32 v28, v16, v20
    v_lshlrev_b32 v29, 16, v28
    v_and_b32 v30, 0xffff0000, v28
    v_add_f32 v29, v29, v184
    v_add_f32 v30, v30, v185
    v_cvt_pk_bf16_f32 v44, v29, v30
    v_cvt_pk_bf16_f32 v32, v17, v21
    v_lshlrev_b32 v33, 16, v32
    v_and_b32 v34, 0xffff0000, v32
    v_add_f32 v33, v33, v186
    v_add_f32 v34, v34, v187
    v_cvt_pk_bf16_f32 v45, v33, v34
    v_cvt_pk_bf16_f32 v36, v18, v22
    v_lshlrev_b32 v37, 16, v36
    v_and_b32 v38, 0xffff0000, v36
    v_add_f32 v37, v37, v188
    v_add_f32 v38, v38, v189
    v_cvt_pk_bf16_f32 v46, v37, v38
    v_cvt_pk_bf16_f32 v40, v19, v23
    v_lshlrev_b32 v41, 16, v40
    v_and_b32 v42, 0xffff0000, v40
    v_add_f32 v41, v41, v190
    v_add_f32 v42, v42, v191
    v_cvt_pk_bf16_f32 v47, v41, v42
    s_add_u32 s32, s13, 2097152
    buffer_store_dwordx4 v[44:47], v14, s[28:31], s32 offen
L_convA_kernel_end:
    s_endpgm

.globl row1_kernel
.p2align 8
.type row1_kernel,@function
row1_kernel:
    s_cmp_ge_u32 s2, 256
    s_cbranch_scc1 L_row1_kernel_end_kgen
    s_setprio 3
    s_load_dwordx2 s[10:11], s[0:1], 120
    s_load_dwordx2 s[4:5], s[0:1], 0
    s_and_b32 s3, s2, 7
    s_lshl_b32 s3, s3, 5
    s_lshr_b32 s12, s2, 3
    s_add_u32 s3, s3, s12
    v_and_b32 v1, 7, v0
    v_lshrrev_b32 v2, 3, v0
    s_lshl_b32 s13, s3, 3
    v_add_u32 v3, s13, v1
    v_lshlrev_b32 v9, 15, v2
    v_lshl_add_u32 v8, v3, 2, v9
    v_lshl_add_u32 v9, v3, 4, v9
    s_waitcnt lgkmcnt(0)
    s_mov_b32 s28, s10
    s_and_b32 s29, s11, 0xffff
    s_mov_b32 s30, 268435456
    s_mov_b32 s31, 0x00020000
    s_mov_b32 s32, 2097152
    s_mov_b32 s16, s4
    s_and_b32 s17, s5, 0xffff
    s_mov_b32 s18, 2097152
    s_mov_b32 s19, 0x00020000
    v_lshlrev_b32 v7, 10, v3
    v_lshl_add_u32 v4, v2, 4, v7
    buffer_load_dwordx4 v[16:19], v4, s[16:19], 0 offen
    buffer_load_dword v20, v7, s[16:19], 0 offen
    s_add_u32 s34, s32, 0
    buffer_load_dword v12, v8, s[28:31], s34 offen
    s_add_u32 s34, s32, 8192
    buffer_load_dword v13, v8, s[28:31], s34 offen
    s_add_u32 s34, s32, 16384
    buffer_load_dword v14, v8, s[28:31], s34 offen
    s_add_u32 s34, s32, 24576
    buffer_load_dword v15, v8, s[28:31], s34 offen
    s_mov_b32 s48, 0xff
    s_mov_b32 s49, 0xff
    v_lshlrev_b32 v11, 5, v1
    v_bfe_u32 v10, v0, 5, 1
    v_lshl_add_u32 v10, v10, 8, v11
    v_lshrrev_b32 v5, 6, v0
    v_lshl_add_u32 v10, v5, 2, v10
    s_waitcnt vmcnt(4)
    v_lshlrev_b32 v20, 16, v20
    v_lshlrev_b32 v24, 16, v16
    v_and_b32 v25, 0xffff0000, v16
    v_lshlrev_b32 v26, 16, v17
    v_and_b32 v27, 0xffff0000, v17
    v_lshlrev_b32 v28, 16, v18
    v_and_b32 v29, 0xffff0000, v18
    v_lshlrev_b32 v30, 16, v19
    v_and_b32 v31, 0xffff0000, v19
    v_sub_f32 v48, v24, v20
    v_sub_f32 v49, v25, v20
    v_sub_f32 v50, v26, v20
    v_sub_f32 v51, v27, v20
    v_sub_f32 v52, v28, v20
    v_sub_f32 v53, v29, v20
    v_sub_f32 v54, v30, v20
    v_sub_f32 v55, v31, v20
    v_add_f32 v40, v48, v49
    v_mul_f32 v41, v48, v48
    v_mul_f32 v42, v49, v49
    v_add_f32 v43, v50, v51
    v_fmac_f32 v41, v50, v50
    v_fmac_f32 v42, v51, v51
    v_add_f32 v40, v40, v43
    v_add_f32 v43, v52, v53
    v_fmac_f32 v41, v52, v52
    v_fmac_f32 v42, v53, v53
    v_add_f32 v40, v40, v43
    v_add_f32 v43, v54, v55
    v_fmac_f32 v41, v54, v54
    v_fmac_f32 v42, v55, v55
    v_add_f32 v40, v40, v43
    v_add_f32 v41, v41, v42
    s_nop 1
    v_permlane32_swap_b32 v40, v41
    v_add_f32 v40, v40, v41
    v_mov_b32 v42, v40
    s_nop 1
    v_permlane16_swap_b32 v40, v42
    v_add_f32 v40, v40, v42
    s_nop 1
    v_add_f32_dpp v40, v40, v40 row_ror:8 row_mask:0xf bank_mask:0xf
    s_mov_b64 exec, s[48:49]
    ds_write_b32 v10, v40 offset:0
    s_mov_b64 exec, -1
    s_waitcnt lgkmcnt(0)
    s_barrier
    ds_read_b128 v[48:51], v11 offset:0
    ds_read_b128 v[52:55], v11 offset:16
    ds_read_b128 v[56:59], v11 offset:256
    ds_read_b128 v[60:63], v11 offset:272
    s_waitcnt lgkmcnt(2)
    v_add_f32 v48, v48, v49
    v_add_f32 v50, v50, v51
    v_add_f32 v52, v52, v53
    v_add_f32 v54, v54, v55
    v_add_f32 v48, v48, v50
    v_add_f32 v52, v52, v54
    v_add_f32 v48, v48, v52
    s_waitcnt lgkmcnt(0)
    v_add_f32 v56, v56, v57
    v_add_f32 v58, v58, v59
    v_add_f32 v60, v60, v61
    v_add_f32 v62, v62, v63
    v_add_f32 v56, v56, v58
    v_add_f32 v60, v60, v62
    v_add_f32 v56, v56, v60
    v_mul_f32 v48, 0x3b000000, v48
    v_mul_f32 v49, 0x3b000000, v56
    v_add_f32 v21, v20, v48
    v_fma_f32 v49, -v48, v48, v49
    v_max_f32 v49, 0, v49
    v_cvt_pk_bf16_f32 v50, v21, v49
    v_lshlrev_b32 v22, 16, v50
    v_and_b32 v49, 0xffff0000, v50
    v_add_f32 v49, 0x3727c5ac, v49
    v_cvt_pk_bf16_f32 v49, v49, v49
    v_and_b32 v49, 0xffff0000, v49
    v_sqrt_f32 v49, v49
    s_nop 0
    v_cvt_pk_bf16_f32 v49, v49, v49
    v_and_b32 v23, 0xffff0000, v49
    v_rcp_f32 v36, v23
    s_waitcnt vmcnt(0)
    v_sub_f32 v51, v24, v22
    v_sub_f32 v52, v25, v22
    v_cvt_pk_bf16_f32 v53, v51, v52
    v_lshlrev_b32 v51, 16, v53
    v_and_b32 v52, 0xffff0000, v53
    v_mul_f32 v54, v51, v36
    v_fma_f32 v55, -v54, v23, v51
    v_fma_f32 v51, v55, v36, v54
    v_mul_f32 v54, v52, v36
    v_fma_f32 v55, -v54, v23, v52
    v_fma_f32 v52, v55, v36, v54
    v_cvt_pk_bf16_f32 v53, v51, v52
    v_lshlrev_b32 v51, 16, v53
    v_and_b32 v52, 0xffff0000, v53
    v_lshlrev_b32 v54, 16, v12
    v_and_b32 v55, 0xffff0000, v12
    v_mul_f32 v51, v51, v54
    v_mul_f32 v52, v52, v55
    v_cvt_pk_bf16_f32 v53, v51, v52
    v_lshlrev_b32 v51, 16, v53
    v_and_b32 v52, 0xffff0000, v53
    v_add_f32 v51, v51, v24
    v_add_f32 v52, v52, v25
    v_cvt_pk_bf16_f32 v56, v51, v52
    v_lshlrev_b32 v24, 16, v56
    v_and_b32 v25, 0xffff0000, v56
    v_sub_f32 v51, v26, v22
    v_sub_f32 v52, v27, v22
    v_cvt_pk_bf16_f32 v53, v51, v52
    v_lshlrev_b32 v51, 16, v53
    v_and_b32 v52, 0xffff0000, v53
    v_mul_f32 v54, v51, v36
    v_fma_f32 v55, -v54, v23, v51
    v_fma_f32 v51, v55, v36, v54
    v_mul_f32 v54, v52, v36
    v_fma_f32 v55, -v54, v23, v52
    v_fma_f32 v52, v55, v36, v54
    v_cvt_pk_bf16_f32 v53, v51, v52
    v_lshlrev_b32 v51, 16, v53
    v_and_b32 v52, 0xffff0000, v53
    v_lshlrev_b32 v54, 16, v13
    v_and_b32 v55, 0xffff0000, v13
    v_mul_f32 v51, v51, v54
    v_mul_f32 v52, v52, v55
    v_cvt_pk_bf16_f32 v53, v51, v52
    v_lshlrev_b32 v51, 16, v53
    v_and_b32 v52, 0xffff0000, v53
    v_add_f32 v51, v51, v26
    v_add_f32 v52, v52, v27
    v_cvt_pk_bf16_f32 v57, v51, v52
    v_lshlrev_b32 v26, 16, v57
    v_and_b32 v27, 0xffff0000, v57
    v_sub_f32 v51, v28, v22
    v_sub_f32 v52, v29, v22
    v_cvt_pk_bf16_f32 v53, v51, v52
    v_lshlrev_b32 v51, 16, v53
    v_and_b32 v52, 0xffff0000, v53
    v_mul_f32 v54, v51, v36
    v_fma_f32 v55, -v54, v23, v51
    v_fma_f32 v51, v55, v36, v54
    v_mul_f32 v54, v52, v36
    v_fma_f32 v55, -v54, v23, v52
    v_fma_f32 v52, v55, v36, v54
    v_cvt_pk_bf16_f32 v53, v51, v52
    v_lshlrev_b32 v51, 16, v53
    v_and_b32 v52, 0xffff0000, v53
    v_lshlrev_b32 v54, 16, v14
    v_and_b32 v55, 0xffff0000, v14
    v_mul_f32 v51, v51, v54
    v_mul_f32 v52, v52, v55
    v_cvt_pk_bf16_f32 v53, v51, v52
    v_lshlrev_b32 v51, 16, v53
    v_and_b32 v52, 0xffff0000, v53
    v_add_f32 v51, v51, v28
    v_add_f32 v52, v52, v29
    v_cvt_pk_bf16_f32 v58, v51, v52
    v_lshlrev_b32 v28, 16, v58
    v_and_b32 v29, 0xffff0000, v58
    v_sub_f32 v51, v30, v22
    v_sub_f32 v52, v31, v22
    v_cvt_pk_bf16_f32 v53, v51, v52
    v_lshlrev_b32 v51, 16, v53
    v_and_b32 v52, 0xffff0000, v53
    v_mul_f32 v54, v51, v36
    v_fma_f32 v55, -v54, v23, v51
    v_fma_f32 v51, v55, v36, v54
    v_mul_f32 v54, v52, v36
    v_fma_f32 v55, -v54, v23, v52
    v_fma_f32 v52, v55, v36, v54
    v_cvt_pk_bf16_f32 v53, v51, v52
    v_lshlrev_b32 v51, 16, v53
    v_and_b32 v52, 0xffff0000, v53
    v_lshlrev_b32 v54, 16, v15
    v_and_b32 v55, 0xffff0000, v15
    v_mul_f32 v51, v51, v54
    v_mul_f32 v52, v52, v55
    v_cvt_pk_bf16_f32 v53, v51, v52
    v_lshlrev_b32 v51, 16, v53
    v_and_b32 v52, 0xffff0000, v53
    v_add_f32 v51, v51, v30
    v_add_f32 v52, v52, v31
    v_cvt_pk_bf16_f32 v59, v51, v52
    v_lshlrev_b32 v30, 16, v59
    v_and_b32 v31, 0xffff0000, v59
    s_mov_b32 s34, 4194304
    buffer_store_dword v56, v8, s[28:31], s34 offen
    s_mov_b32 s34, 4202496
    buffer_store_dword v57, v8, s[28:31], s34 offen
    s_mov_b32 s34, 4210688
    buffer_store_dword v58, v8, s[28:31], s34 offen
    s_mov_b32 s34, 4218880
    buffer_store_dword v59, v8, s[28:31], s34 offen
    v_sub_f32 v48, v24, v21
    v_sub_f32 v49, v25, v21
    v_sub_f32 v50, v26, v21
    v_sub_f32 v51, v27, v21
    v_sub_f32 v52, v28, v21
    v_sub_f32 v53, v29, v21
    v_sub_f32 v54, v30, v21
    v_sub_f32 v55, v31, v21
    v_add_f32 v40, v48, v49
    v_mul_f32 v41, v48, v48
    v_mul_f32 v42, v49, v49
    v_add_f32 v43, v50, v51
    v_fmac_f32 v41, v50, v50
    v_fmac_f32 v42, v51, v51
    v_add_f32 v40, v40, v43
    v_add_f32 v43, v52, v53
    v_fmac_f32 v41, v52, v52
    v_fmac_f32 v42, v53, v53
    v_add_f32 v40, v40, v43
    v_add_f32 v43, v54, v55
    v_fmac_f32 v41, v54, v54
    v_fmac_f32 v42, v55, v55
    v_add_f32 v40, v40, v43
    v_add_f32 v41, v41, v42
    s_nop 1
    v_permlane32_swap_b32 v40, v41
    v_add_f32 v40, v40, v41
    v_mov_b32 v42, v40
    s_nop 1
    v_permlane16_swap_b32 v40, v42
    v_add_f32 v40, v40, v42
    s_nop 1
    v_add_f32_dpp v40, v40, v40 row_ror:8 row_mask:0xf bank_mask:0xf
    s_mov_b64 exec, s[48:49]
    ds_write_b32 v10, v40 offset:512
    s_mov_b64 exec, -1
    s_waitcnt lgkmcnt(0)
    s_barrier
    v_cmp_gt_u32 vcc, 8, v0
    s_nop 0
    s_and_saveexec_b64 s[36:37], vcc
    s_cbranch_execz L_row1_kernel_end
    ds_read_b128 v[64:67], v11 offset:512
    ds_read_b128 v[68:71], v11 offset:528
    ds_read_b128 v[72:75], v11 offset:768
    ds_read_b128 v[76:79], v11 offset:784
    s_waitcnt lgkmcnt(2)
    v_add_f32 v64, v64, v65
    v_add_f32 v66, v66, v67
    v_add_f32 v68, v68, v69
    v_add_f32 v70, v70, v71
    v_add_f32 v64, v64, v66
    v_add_f32 v68, v68, v70
    v_add_f32 v64, v64, v68
    s_waitcnt lgkmcnt(0)
    v_add_f32 v72, v72, v73
    v_add_f32 v74, v74, v75
    v_add_f32 v76, v76, v77
    v_add_f32 v78, v78, v79
    v_add_f32 v72, v72, v74
    v_add_f32 v76, v76, v78
    v_add_f32 v72, v72, v76
    v_mul_f32 v64, 0x3b000000, v64
    v_mul_f32 v65, 0x3b000000, v72
    v_add_f32 v60, v21, v64
    v_fma_f32 v65, -v64, v64, v65
    v_max_f32 v65, 0, v65
    v_cvt_pk_bf16_f32 v66, v60, v65
    v_lshlrev_b32 v61, 16, v66
    v_and_b32 v65, 0xffff0000, v66
    v_add_f32 v65, 0x3727c5ac, v65
    v_cvt_pk_bf16_f32 v65, v65, v65
    v_and_b32 v65, 0xffff0000, v65
    v_sqrt_f32 v65, v65
    s_nop 0
    v_cvt_pk_bf16_f32 v65, v65, v65
    v_and_b32 v62, 0xffff0000, v65
    v_lshrrev_b32 v61, 16, v61
    v_or_b32 v61, v61, v62
    v_lshlrev_b32 v7, 2, v3
    s_mov_b32 s35, 10485760
    buffer_store_dword v61, v7, s[28:31], s35 offen
    s_endpgm
L_row1_kernel_end_kgen:
    s_cmp_ge_u32 s2, 256
    s_cbranch_scc1 L_row1_kernel_end
L_row1_kernel_end:
    s_endpgm

.globl convB1_kernel
.p2align 8
.type convB1_kernel,@function
convB1_kernel:
    s_cmp_ge_u32 s2, 256
    s_cbranch_scc1 L_convB1_kernel_end
    s_load_dwordx2 s[10:11], s[0:1], 120
    s_load_dwordx4 s[4:7], s[0:1], 96
    s_and_b32 s3, s2, 7
    s_lshl_b32 s3, s3, 5
    s_lshr_b32 s12, s2, 3
    s_add_u32 s3, s3, s12
    v_lshrrev_b32 v1, 6, v0
    v_and_b32 v2, 63, v0
    v_lshlrev_b32 v14, 4, v0
    v_readfirstlane_b32 s14, v1
    s_lshl_b32 s13, s3, 13
    s_lshl_b32 s15, s3, 2
    s_waitcnt lgkmcnt(0)
    s_mov_b32 s28, s10
    s_and_b32 s29, s11, 0xffff
    s_mov_b32 s30, 268435456
    s_mov_b32 s31, 0x00020000
    s_add_u32 s32, s13, 4194304
    buffer_load_dwordx4 v[4:7], v14, s[28:31], s32 offen
    s_mov_b32 s34, 10485760
    buffer_load_dwordx4 v[48:51], v14, s[28:31], s34 offen
    s_lshl_b32 s35, s3, 13
    s_add_u32 s35, s35, 12582912
    buffer_load_dwordx4 v[52:55], v14, s[28:31], s35 offen
    s_add_u32 s4, s4, s15
    s_addc_u32 s5, s5, 0
    s_load_dword s33, s[4:5], 0
    v_mov_b32 v64, 0
    v_mov_b32 v65, 0
    v_mov_b32 v66, 0
    v_mov_b32 v67, 0
    v_lshrrev_b32 v61, 4, v0
    v_mul_u32_u24 v61, 1152, v61
    v_and_b32 v62, 15, v0
    v_lshl_add_u32 v61, v62, 3, v61
    v_cmp_gt_u32 vcc, 128, v0
    s_nop 0
    s_and_saveexec_b64 s[36:37], vcc
    ds_write_b64 v61, v[64:65] offset:8320
    ds_write_b64 v61, v[64:65] offset:17672
    s_mov_b64 exec, s[36:37]
    v_lshrrev_b32 v61, 1, v0
    v_mul_u32_u24 v61, 4160, v61
    v_and_b32 v62, 1, v0
    v_lshl_add_u32 v61, v62, 4, v61
    v_cmp_gt_u32 vcc, 4, v0
    s_nop 0
    s_and_saveexec_b64 s[36:37], vcc
    ds_write_b128 v61, v[64:67] offset:0
    s_mov_b64 exec, s[36:37]
    s_mov_b32 s38, 0x05040100
    s_mov_b32 s39, 0x07060302
    s_lshr_b32 s40, s14, 2
    s_and_b32 s41, s14, 3
    s_mul_i32 s42, s40, 4160
    s_add_u32 s42, s42, 32
    s_mul_i32 s43, s40, 4
    s_add_u32 s43, s43, s41
    s_mul_i32 s43, s43, 1152
    s_add_u32 s43, s43, 8376
    v_lshrrev_b32 v70, 4, v2
    v_and_b32 v71, 3, v2
    v_bfe_u32 v72, v2, 2, 2
    v_sub_u32 v71, v71, v72
    v_lshlrev_b32 v71, 3, v71
    v_lshl_add_u32 v71, v70, 6, v71
    v_add_u32 v12, s42, v71
    v_and_b32 v71, 15, v2
    v_lshlrev_b32 v71, 3, v71
    v_lshlrev_b32 v72, 4, v70
    v_sub_u32 v71, v71, v72
    v_add_u32 v13, s43, v71
    v_and_b32 v71, 1, v2
    v_xor_b32 v71, 1, v71
    v_mul_u32_u24 v71, 9352, v71
    v_add_u32 v13, v13, v71
    v_mov_b32 v16, 0
    v_mov_b32 v17, 0
    v_mov_b32 v18, 0
    v_mov_b32 v19, 0
    v_mov_b32 v20, 0
    v_mov_b32 v21, 0
    v_mov_b32 v22, 0
    v_mov_b32 v23, 0
    v_mov_b32 v24, 0
    v_mov_b32 v25, 0
    v_mov_b32 v26, 0
    v_mov_b32 v27, 0
    v_mov_b32 v28, 0
    v_mov_b32 v29, 0
    v_mov_b32 v30, 0
    v_mov_b32 v31, 0
    v_mov_b32 v32, 0
    v_mov_b32 v33, 0
    v_mov_b32 v34, 0
    v_mov_b32 v35, 0
    v_mov_b32 v36, 0
    v_mov_b32 v37, 0
    v_mov_b32 v38, 0
    v_mov_b32 v39, 0
    v_mov_b32 v40, 0
    v_mov_b32 v41, 0
    v_mov_b32 v42, 0
    v_mov_b32 v43, 0
    v_mov_b32 v44, 0
    v_mov_b32 v45, 0
    v_mov_b32 v46, 0
    v_mov_b32 v47, 0
    v_and_b32 v70, 15, v2
    v_lshrrev_b32 v71, 4, v2
    v_lshlrev_b32 v72, 2, v71
    v_xor_b32 v70, v70, v72
    v_lshl_add_u32 v70, v71, 4, v70
    v_lshlrev_b32 v70, 4, v70
    s_mul_i32 s44, s14, 8208
    s_add_u32 s44, s44, 27136
    v_add_u32 v176, s44, v70
    v_mov_b32 v70, s44
    s_mov_b64 exec, 1
    ds_write_b128 v70, v[64:67] offset:8192
    s_mov_b64 exec, -1
    v_lshrrev_b32 v70, 2, v2
    v_and_b32 v71, 3, v2
    v_lshlrev_b32 v72, 2, v71
    v_xor_b32 v70, v70, v72
    v_lshl_add_u32 v70, v71, 4, v70
    v_lshlrev_b32 v70, 4, v70
    s_lshl_b32 s44, s14, 10
    s_add_u32 s44, s44, 27136
    v_add_u32 v177, s44, v70
    v_subrev_u32 v73, 1, v2
    v_lshrrev_b32 v71, 2, v73
    v_and_b32 v73, 3, v73
    v_lshlrev_b32 v72, 2, v73
    v_xor_b32 v71, v71, v72
    v_lshl_add_u32 v71, v73, 4, v71
    v_lshlrev_b32 v71, 4, v71
    v_add_u32 v71, s44, v71
    s_sub_u32 s45, s44, 208
    s_cmp_eq_u32 s14, 0
    s_cselect_b32 s45, 35328, s45
    v_mov_b32 v72, s45
    v_cmp_eq_u32 vcc, 0, v2
    s_nop 1
    v_cndmask_b32 v178, v71, v72, vcc
    v_add_u32 v179, 32832, v177
    v_add_u32 v180, 32832, v178
    v_lshlrev_b32 v62, 3, v0
    v_mul_u32_u24 v61, 1152, v1
    v_lshl_add_u32 v61, v2, 4, v61
    s_waitcnt vmcnt(1)
    v_lshlrev_b32 v72, 16, v48
    v_and_b32 v73, 0xffff0000, v48
    v_rcp_f32 v74, v73
    v_lshlrev_b32 v192, 16, v4
    v_and_b32 v193, 0xffff0000, v4
    v_lshlrev_b32 v80, 16, v49
    v_and_b32 v81, 0xffff0000, v49
    v_rcp_f32 v82, v81
    v_lshlrev_b32 v194, 16, v5
    v_and_b32 v195, 0xffff0000, v5
    v_lshlrev_b32 v88, 16, v50
    v_and_b32 v89, 0xffff0000, v50
    v_rcp_f32 v90, v89
    v_lshlrev_b32 v196, 16, v6
    v_and_b32 v197, 0xffff0000, v6
    v_lshlrev_b32 v96, 16, v51
    v_and_b32 v97, 0xffff0000, v51
    v_rcp_f32 v98, v97
    v_lshlrev_b32 v198, 16, v7
    v_and_b32 v199, 0xffff0000, v7
    v_sub_f32 v75, v192, v72
    v_sub_f32 v76, v193, v72
    v_cvt_pk_bf16_f32 v77, v75, v76
    v_lshlrev_b32 v75, 16, v77
    v_and_b32 v76, 0xffff0000, v77
    v_mul_f32 v78, v75, v74
    v_fma_f32 v79, -v78, v73, v75
    v_fma_f32 v75, v79, v74, v78
    v_mul_f32 v78, v76, v74
    v_fma_f32 v79, -v78, v73, v76
    v_fma_f32 v76, v79, v74, v78
    v_cvt_pk_bf16_f32 v8, v75, v76
    v_sub_f32 v83, v194, v80
    v_sub_f32 v84, v195, v80
    v_cvt_pk_bf16_f32 v85, v83, v84
    v_lshlrev_b32 v83, 16, v85
    v_and_b32 v84, 0xffff0000, v85
    v_mul_f32 v86, v83, v82
    v_fma_f32 v87, -v86, v81, v83
    v_fma_f32 v83, v87, v82, v86
    v_mul_f32 v86, v84, v82
    v_fma_f32 v87, -v86, v81, v84
    v_fma_f32 v84, v87, v82, v86
    v_cvt_pk_bf16_f32 v9, v83, v84
    v_sub_f32 v91, v196, v88
    v_sub_f32 v92, v197, v88
    v_cvt_pk_bf16_f32 v93, v91, v92
    v_lshlrev_b32 v91, 16, v93
    v_and_b32 v92, 0xffff0000, v93
    v_mul_f32 v94, v91, v90
    v_fma_f32 v95, -v94, v89, v91
    v_fma_f32 v91, v95, v90, v94
    v_mul_f32 v94, v92, v90
    v_fma_f32 v95, -v94, v89, v92
    v_fma_f32 v92, v95, v90, v94
    v_cvt_pk_bf16_f32 v10, v91, v92
    v_sub_f32 v99, v198, v96
    v_sub_f32 v100, v199, v96
    v_cvt_pk_bf16_f32 v101, v99, v100
    v_lshlrev_b32 v99, 16, v101
    v_and_b32 v100, 0xffff0000, v101
    v_mul_f32 v102, v99, v98
    v_fma_f32 v103, -v102, v97, v99
    v_fma_f32 v99, v103, v98, v102
    v_mul_f32 v102, v100, v98
    v_fma_f32 v103, -v102, v97, v100
    v_fma_f32 v100, v103, v98, v102
    v_cvt_pk_bf16_f32 v11, v99, v100
    v_perm_b32 v64, v9, v8, s38
    v_perm_b32 v65, v11, v10, s38
    v_perm_b32 v66, v9, v8, s39
    v_perm_b32 v67, v11, v10, s39
    ds_write_b64 v62, v[64:65] offset:32
    ds_write_b64 v62, v[66:67] offset:4192
    s_waitcnt vmcnt(0)
    ds_write_b128 v61, v[52:55] offset:8448
    ds_write_b64 v61, v[52:53] offset:17800
    ds_write_b64 v61, v[54:55] offset:17808
    s_waitcnt lgkmcnt(0)
    s_lshl_b32 s46, s33, 16
    s_and_b32 s47, s33, 0xffff0000
    s_barrier
    ds_read_b64_tr_b16 v[48:49], v12 offset:32
    ds_read_b64_tr_b16 v[50:51], v12 offset:0
    ds_read_b128 v[80:83], v13 offset:64
    ds_read_b128 v[84:87], v13 offset:192
    ds_read_b64_tr_b16 v[52:53], v12 offset:544
    ds_read_b64_tr_b16 v[54:55], v12 offset:512
    ds_read_b128 v[88:91], v13 offset:320
    ds_read_b64_tr_b16 v[56:57], v12 offset:1056
    ds_read_b64_tr_b16 v[58:59], v12 offset:1024
    ds_read_b128 v[92:95], v13 offset:448
    ds_read_b64_tr_b16 v[60:61], v12 offset:1568
    ds_read_b64_tr_b16 v[62:63], v12 offset:1536
    ds_read_b128 v[96:99], v13 offset:576
    ds_read_b64_tr_b16 v[64:65], v12 offset:2080
    ds_read_b64_tr_b16 v[66:67], v12 offset:2048
    ds_read_b128 v[100:103], v13 offset:704
    ds_read_b64_tr_b16 v[68:69], v12 offset:2592
    ds_read_b64_tr_b16 v[70:71], v12 offset:2560
    ds_read_b128 v[104:107], v13 offset:832
    ds_read_b64_tr_b16 v[72:73], v12 offset:3104
    ds_read_b64_tr_b16 v[74:75], v12 offset:3072
    ds_read_b128 v[108:111], v13 offset:960
    ds_read_b64_tr_b16 v[76:77], v12 offset:3616
    ds_read_b64_tr_b16 v[78:79], v12 offset:3584
    s_waitcnt lgkmcnt(15)
    v_mfma_f32_16x16x32_bf16 v[16:19], v[48:51], v[80:83], v[16:19]
    ds_read_b64_tr_b16 v[112:113], v12 offset:288
    v_mfma_f32_16x16x32_bf16 v[20:23], v[48:51], v[84:87], v[20:23]
    ds_read_b64_tr_b16 v[114:115], v12 offset:256
    v_mfma_f32_16x16x32_bf16 v[20:23], v[52:55], v[80:83], v[20:23]
    ds_read_b128 v[144:147], v13 offset:0
    v_mfma_f32_16x16x32_bf16 v[24:27], v[48:51], v[88:91], v[24:27]
    ds_read_b128 v[148:151], v13 offset:128
    v_mfma_f32_16x16x32_bf16 v[24:27], v[52:55], v[84:87], v[24:27]
    ds_read_b64_tr_b16 v[116:117], v12 offset:800
    v_mfma_f32_16x16x32_bf16 v[24:27], v[56:59], v[80:83], v[24:27]
    ds_read_b64_tr_b16 v[118:119], v12 offset:768
    s_waitcnt lgkmcnt(15)
    v_mfma_f32_16x16x32_bf16 v[28:31], v[48:51], v[92:95], v[28:31]
    ds_read_b128 v[152:155], v13 offset:256
    v_mfma_f32_16x16x32_bf16 v[28:31], v[52:55], v[88:91], v[28:31]
    ds_read_b64_tr_b16 v[120:121], v12 offset:1312
    v_mfma_f32_16x16x32_bf16 v[28:31], v[56:59], v[84:87], v[28:31]
    ds_read_b64_tr_b16 v[122:123], v12 offset:1280
    v_mfma_f32_16x16x32_bf16 v[28:31], v[60:63], v[80:83], v[28:31]
    ds_read_b128 v[156:159], v13 offset:384
    v_mfma_f32_16x16x32_bf16 v[32:35], v[48:51], v[96:99], v[32:35]
    ds_read_b64_tr_b16 v[124:125], v12 offset:1824
    v_mfma_f32_16x16x32_bf16 v[32:35], v[52:55], v[92:95], v[32:35]
    ds_read_b64_tr_b16 v[126:127], v12 offset:1792
    v_mfma_f32_16x16x32_bf16 v[32:35], v[56:59], v[88:91], v[32:35]
    ds_read_b128 v[160:163], v13 offset:512
    v_mfma_f32_16x16x32_bf16 v[32:35], v[60:63], v[84:87], v[32:35]
    ds_read_b64_tr_b16 v[128:129], v12 offset:2336
    v_mfma_f32_16x16x32_bf16 v[32:35], v[64:67], v[80:83], v[32:35]
    ds_read_b64_tr_b16 v[130:131], v12 offset:2304
    s_waitcnt lgkmcnt(15)
    v_mfma_f32_16x16x32_bf16 v[36:39], v[48:51], v[100:103], v[36:39]
    ds_read_b128 v[164:167], v13 offset:640
    v_mfma_f32_16x16x32_bf16 v[36:39], v[52:55], v[96:99], v[36:39]
    ds_read_b64_tr_b16 v[132:133], v12 offset:2848
    v_mfma_f32_16x16x32_bf16 v[36:39], v[56:59], v[92:95], v[36:39]
    ds_read_b64_tr_b16 v[134:135], v12 offset:2816
    v_mfma_f32_16x16x32_bf16 v[36:39], v[60:63], v[88:91], v[36:39]
    ds_read_b128 v[168:171], v13 offset:768
    v_mfma_f32_16x16x32_bf16 v[36:39], v[64:67], v[84:87], v[36:39]
    ds_read_b64_tr_b16 v[136:137], v12 offset:3360
    v_mfma_f32_16x16x32_bf16 v[36:39], v[68:71], v[80:83], v[36:39]
    ds_read_b64_tr_b16 v[138:139], v12 offset:3328
    v_mfma_f32_16x16x32_bf16 v[40:43], v[48:51], v[104:107], v[40:43]
    ds_read_b128 v[172:175], v13 offset:896
    v_mfma_f32_16x16x32_bf16 v[40:43], v[52:55], v[100:103], v[40:43]
    ds_read_b64_tr_b16 v[140:141], v12 offset:3872
    v_mfma_f32_16x16x32_bf16 v[40:43], v[56:59], v[96:99], v[40:43]
    ds_read_b64_tr_b16 v[142:143], v12 offset:3840
    v_mfma_f32_16x16x32_bf16 v[40:43], v[60:63], v[92:95], v[40:43]
    v_lshlrev_b32 v184, 16, v8
    v_mfma_f32_16x16x32_bf16 v[40:43], v[64:67], v[88:91], v[40:43]
    v_and_b32 v185, 0xffff0000, v8
    v_mfma_f32_16x16x32_bf16 v[40:43], v[68:71], v[84:87], v[40:43]
    v_mul_f32 v184, s46, v184
    v_mfma_f32_16x16x32_bf16 v[40:43], v[72:75], v[80:83], v[40:43]
    v_mul_f32 v185, s47, v185
    v_mfma_f32_16x16x32_bf16 v[44:47], v[48:51], v[108:111], v[44:47]
    v_cvt_pk_bf16_f32 v15, v184, v185
    v_mfma_f32_16x16x32_bf16 v[44:47], v[52:55], v[104:107], v[44:47]
    v_lshlrev_b32 v184, 16, v15
    v_mfma_f32_16x16x32_bf16 v[44:47], v[56:59], v[100:103], v[44:47]
    v_and_b32 v185, 0xffff0000, v15
    v_mfma_f32_16x16x32_bf16 v[44:47], v[60:63], v[96:99], v[44:47]
    v_lshlrev_b32 v186, 16, v9
    v_mfma_f32_16x16x32_bf16 v[44:47], v[64:67], v[92:95], v[44:47]
    v_and_b32 v187, 0xffff0000, v9
    v_mfma_f32_16x16x32_bf16 v[44:47], v[68:71], v[88:91], v[44:47]
    v_mul_f32 v186, s46, v186
    v_mfma_f32_16x16x32_bf16 v[44:47], v[72:75], v[84:87], v[44:47]
    v_mul_f32 v187, s47, v187
    v_mfma_f32_16x16x32_bf16 v[44:47], v[76:79], v[80:83], v[44:47]
    v_cvt_pk_bf16_f32 v15, v186, v187
    s_waitcnt lgkmcnt(15)
    v_mfma_f32_16x16x32_bf16 v[16:19], v[112:115], v[144:147], v[16:19]
    v_lshlrev_b32 v186, 16, v15
    v_mfma_f32_16x16x32_bf16 v[20:23], v[112:115], v[148:151], v[20:23]
    v_and_b32 v187, 0xffff0000, v15
    v_mfma_f32_16x16x32_bf16 v[20:23], v[116:119], v[144:147], v[20:23]
    v_lshlrev_b32 v188, 16, v10
    v_mfma_f32_16x16x32_bf16 v[24:27], v[112:115], v[152:155], v[24:27]
    v_and_b32 v189, 0xffff0000, v10
    v_mfma_f32_16x16x32_bf16 v[24:27], v[116:119], v[148:151], v[24:27]
    v_mul_f32 v188, s46, v188
    v_mfma_f32_16x16x32_bf16 v[24:27], v[120:123], v[144:147], v[24:27]
    v_mul_f32 v189, s47, v189
    ds_write_b128 v176, v[16:19] offset:0
    s_waitcnt lgkmcnt(15)
    v_mfma_f32_16x16x32_bf16 v[28:31], v[112:115], v[156:159], v[28:31]
    v_cvt_pk_bf16_f32 v15, v188, v189
    v_mfma_f32_16x16x32_bf16 v[28:31], v[116:119], v[152:155], v[28:31]
    v_lshlrev_b32 v188, 16, v15
    ds_write_b128 v176, v[20:23] offset:1024
    v_mfma_f32_16x16x32_bf16 v[28:31], v[120:123], v[148:151], v[28:31]
    v_and_b32 v189, 0xffff0000, v15
    s_waitcnt lgkmcnt(14)
    v_mfma_f32_16x16x32_bf16 v[28:31], v[124:127], v[144:147], v[28:31]
    v_lshlrev_b32 v190, 16, v11
    s_waitcnt lgkmcnt(13)
    v_mfma_f32_16x16x32_bf16 v[32:35], v[112:115], v[160:163], v[32:35]
    v_and_b32 v191, 0xffff0000, v11
    ds_write_b128 v176, v[24:27] offset:2048
    v_mfma_f32_16x16x32_bf16 v[32:35], v[116:119], v[156:159], v[32:35]
    v_mul_f32 v190, s46, v190
    v_mfma_f32_16x16x32_bf16 v[32:35], v[120:123], v[152:155], v[32:35]
    v_mul_f32 v191, s47, v191
    v_mfma_f32_16x16x32_bf16 v[32:35], v[124:127], v[148:151], v[32:35]
    v_cvt_pk_bf16_f32 v15, v190, v191
    s_waitcnt lgkmcnt(12)
    v_mfma_f32_16x16x32_bf16 v[32:35], v[128:131], v[144:147], v[32:35]
    v_lshlrev_b32 v190, 16, v15
    ds_write_b128 v176, v[28:31] offset:3072
    s_waitcnt lgkmcnt(12)
    v_mfma_f32_16x16x32_bf16 v[36:39], v[112:115], v[164:167], v[36:39]
    v_and_b32 v191, 0xffff0000, v15
    v_mfma_f32_16x16x32_bf16 v[36:39], v[116:119], v[160:163], v[36:39]
    v_mfma_f32_16x16x32_bf16 v[36:39], v[120:123], v[156:159], v[36:39]
    v_mfma_f32_16x16x32_bf16 v[36:39], v[124:127], v[152:155], v[36:39]
    v_mfma_f32_16x16x32_bf16 v[36:39], v[128:131], v[148:151], v[36:39]
    ds_write_b128 v176, v[32:35] offset:4096
    s_waitcnt lgkmcnt(11)
    v_mfma_f32_16x16x32_bf16 v[36:39], v[132:135], v[144:147], v[36:39]
    s_waitcnt lgkmcnt(10)
    v_mfma_f32_16x16x32_bf16 v[40:43], v[112:115], v[168:171], v[40:43]
    v_mfma_f32_16x16x32_bf16 v[40:43], v[116:119], v[164:167], v[40:43]
    v_mfma_f32_16x16x32_bf16 v[40:43], v[120:123], v[160:163], v[40:43]
    v_mfma_f32_16x16x32_bf16 v[40:43], v[124:127], v[156:159], v[40:43]
    v_mfma_f32_16x16x32_bf16 v[40:43], v[128:131], v[152:155], v[40:43]
    s_nop 1
    ds_write_b128 v176, v[36:39] offset:5120
    v_mfma_f32_16x16x32_bf16 v[40:43], v[132:135], v[148:151], v[40:43]
    s_waitcnt lgkmcnt(9)
    v_mfma_f32_16x16x32_bf16 v[40:43], v[136:139], v[144:147], v[40:43]
    s_waitcnt lgkmcnt(8)
    v_mfma_f32_16x16x32_bf16 v[44:47], v[112:115], v[172:175], v[44:47]
    v_mfma_f32_16x16x32_bf16 v[44:47], v[116:119], v[168:171], v[44:47]
    v_mfma_f32_16x16x32_bf16 v[44:47], v[120:123], v[164:167], v[44:47]
    v_mfma_f32_16x16x32_bf16 v[44:47], v[124:127], v[160:163], v[44:47]
    v_mfma_f32_16x16x32_bf16 v[44:47], v[128:131], v[156:159], v[44:47]
    s_nop 1
    ds_write_b128 v176, v[40:43] offset:6144
    v_mfma_f32_16x16x32_bf16 v[44:47], v[132:135], v[152:155], v[44:47]
    v_mfma_f32_16x16x32_bf16 v[44:47], v[136:139], v[148:151], v[44:47]
    s_waitcnt lgkmcnt(7)
    v_mfma_f32_16x16x32_bf16 v[44:47], v[140:143], v[144:147], v[44:47]
    s_nop 7
    ds_write_b128 v176, v[44:47] offset:7168
    s_waitcnt lgkmcnt(0)
    s_barrier
    ds_read_b128 v[48:51], v177 offset:0
    ds_read_b128 v[52:55], v177 offset:8208
    ds_read_b128 v[84:87], v178 offset:8208
    ds_read_b128 v[56:59], v177 offset:16416
    ds_read_b128 v[88:91], v178 offset:16416
    ds_read_b128 v[60:63], v177 offset:24624
    ds_read_b128 v[92:95], v178 offset:24624
    ds_read_b128 v[64:67], v179 offset:0
    ds_read_b128 v[68:71], v179 offset:8208
    ds_read_b128 v[100:103], v180 offset:8208
    ds_read_b128 v[72:75], v179 offset:16416
    ds_read_b128 v[104:107], v180 offset:16416
    ds_read_b128 v[76:79], v179 offset:24624
    ds_read_b128 v[108:111], v180 offset:24624
    s_waitcnt lgkmcnt(7)
    v_add_f32 v16, v48, v87
    v_add_f32 v24, v90, v93
    v_add_f32 v16, v16, v24
    v_add_f32 v17, v49, v52
    v_add_f32 v25, v91, v94
    v_add_f32 v17, v17, v25
    v_add_f32 v18, v50, v53
    v_add_f32 v26, v56, v95
    v_add_f32 v18, v18, v26
    v_add_f32 v19, v51, v54
    v_add_f32 v27, v57, v60
    v_add_f32 v19, v19, v27
    s_waitcnt lgkmcnt(0)
    v_add_f32 v20, v64, v103
    v_add_f32 v24, v106, v109
    v_add_f32 v20, v20, v24
    v_add_f32 v21, v65, v68
    v_add_f32 v25, v107, v110
    v_add_f32 v21, v21, v25
    v_add_f32 v22, v66, v69
    v_add_f32 v26, v72, v111
    v_add_f32 v22, v22, v26
    v_add_f32 v23, v67, v70
    v_add_f32 v27, v73, v76
    v_add_f32 v23, v23, v27
    v_cvt_pk_bf16_f32 v28, v16, v20
    v_lshlrev_b32 v29, 16, v28
    v_and_b32 v30, 0xffff0000, v28
    v_add_f32 v29, v29, v184
    v_add_f32 v30, v30, v185
    v_cvt_pk_bf16_f32 v28, v29, v30
    v_lshlrev_b32 v29, 16, v28
    v_and_b32 v30, 0xffff0000, v28
    v_add_f32 v29, v29, v192
    v_add_f32 v30, v30, v193
    v_cvt_pk_bf16_f32 v44, v29, v30
    v_cvt_pk_bf16_f32 v32, v17, v21
    v_lshlrev_b32 v33, 16, v32
    v_and_b32 v34, 0xffff0000, v32
    v_add_f32 v33, v33, v186
    v_add_f32 v34, v34, v187
    v_cvt_pk_bf16_f32 v32, v33, v34
    v_lshlrev_b32 v33, 16, v32
    v_and_b32 v34, 0xffff0000, v32
    v_add_f32 v33, v33, v194
    v_add_f32 v34, v34, v195
    v_cvt_pk_bf16_f32 v45, v33, v34
    v_cvt_pk_bf16_f32 v36, v18, v22
    v_lshlrev_b32 v37, 16, v36
    v_and_b32 v38, 0xffff0000, v36
    v_add_f32 v37, v37, v188
    v_add_f32 v38, v38, v189
    v_cvt_pk_bf16_f32 v36, v37, v38
    v_lshlrev_b32 v37, 16, v36
    v_and_b32 v38, 0xffff0000, v36
    v_add_f32 v37, v37, v196
    v_add_f32 v38, v38, v197
    v_cvt_pk_bf16_f32 v46, v37, v38
    v_cvt_pk_bf16_f32 v40, v19, v23
    v_lshlrev_b32 v41, 16, v40
    v_and_b32 v42, 0xffff0000, v40
    v_add_f32 v41, v41, v190
    v_add_f32 v42, v42, v191
    v_cvt_pk_bf16_f32 v40, v41, v42
    v_lshlrev_b32 v41, 16, v40
    v_and_b32 v42, 0xffff0000, v40
    v_add_f32 v41, v41, v198
    v_add_f32 v42, v42, v199
    v_cvt_pk_bf16_f32 v47, v41, v42
    s_add_u32 s32, s13, 6291456
    buffer_store_dwordx4 v[44:47], v14, s[28:31], s32 offen
L_convB1_kernel_end:
    s_endpgm

.globl row2_kernel
.p2align 8
.type row2_kernel,@function
row2_kernel:
    s_cmp_ge_u32 s2, 256
    s_cbranch_scc1 L_row2_kernel_end_kgen
    s_setprio 3
    s_load_dwordx2 s[10:11], s[0:1], 120
    s_load_dwordx2 s[4:5], s[0:1], 0
    s_and_b32 s3, s2, 7
    s_lshl_b32 s3, s3, 5
    s_lshr_b32 s12, s2, 3
    s_add_u32 s3, s3, s12
    v_and_b32 v1, 7, v0
    v_lshrrev_b32 v2, 3, v0
    s_lshl_b32 s13, s3, 3
    v_add_u32 v3, s13, v1
    v_lshlrev_b32 v9, 15, v2
    v_lshl_add_u32 v8, v3, 2, v9
    v_lshl_add_u32 v9, v3, 4, v9
    s_waitcnt lgkmcnt(0)
    s_mov_b32 s28, s10
    s_and_b32 s29, s11, 0xffff
    s_mov_b32 s30, 268435456
    s_mov_b32 s31, 0x00020000
    s_mov_b32 s32, 2097152
    s_mov_b32 s33, 6291456
    v_lshlrev_b32 v7, 2, v3
    s_add_u32 s34, s33, 0
    buffer_load_dword v16, v8, s[28:31], s34 offen
    s_add_u32 s34, s33, 8192
    buffer_load_dword v17, v8, s[28:31], s34 offen
    s_add_u32 s34, s33, 16384
    buffer_load_dword v18, v8, s[28:31], s34 offen
    s_add_u32 s34, s33, 24576
    buffer_load_dword v19, v8, s[28:31], s34 offen
    buffer_load_dword v20, v7, s[28:31], s33 offen
    s_add_u32 s34, s32, 0
    buffer_load_dword v12, v8, s[28:31], s34 offen
    s_add_u32 s34, s32, 8192
    buffer_load_dword v13, v8, s[28:31], s34 offen
    s_add_u32 s34, s32, 16384
    buffer_load_dword v14, v8, s[28:31], s34 offen
    s_add_u32 s34, s32, 24576
    buffer_load_dword v15, v8, s[28:31], s34 offen
    s_mov_b32 s48, 0xff
    s_mov_b32 s49, 0xff
    v_lshlrev_b32 v11, 5, v1
    v_bfe_u32 v10, v0, 5, 1
    v_lshl_add_u32 v10, v10, 8, v11
    v_lshrrev_b32 v5, 6, v0
    v_lshl_add_u32 v10, v5, 2, v10
    s_waitcnt vmcnt(4)
    v_lshlrev_b32 v20, 16, v20
    v_lshlrev_b32 v24, 16, v16
    v_and_b32 v25, 0xffff0000, v16
    v_lshlrev_b32 v26, 16, v17
    v_and_b32 v27, 0xffff0000, v17
    v_lshlrev_b32 v28, 16, v18
    v_and_b32 v29, 0xffff0000, v18
    v_lshlrev_b32 v30, 16, v19
    v_and_b32 v31, 0xffff0000, v19
    v_sub_f32 v48, v24, v20
    v_sub_f32 v49, v25, v20
    v_sub_f32 v50, v26, v20
    v_sub_f32 v51, v27, v20
    v_sub_f32 v52, v28, v20
    v_sub_f32 v53, v29, v20
    v_sub_f32 v54, v30, v20
    v_sub_f32 v55, v31, v20
    v_add_f32 v40, v48, v49
    v_mul_f32 v41, v48, v48
    v_mul_f32 v42, v49, v49
    v_add_f32 v43, v50, v51
    v_fmac_f32 v41, v50, v50
    v_fmac_f32 v42, v51, v51
    v_add_f32 v40, v40, v43
    v_add_f32 v43, v52, v53
    v_fmac_f32 v41, v52, v52
    v_fmac_f32 v42, v53, v53
    v_add_f32 v40, v40, v43
    v_add_f32 v43, v54, v55
    v_fmac_f32 v41, v54, v54
    v_fmac_f32 v42, v55, v55
    v_add_f32 v40, v40, v43
    v_add_f32 v41, v41, v42
    s_nop 1
    v_permlane32_swap_b32 v40, v41
    v_add_f32 v40, v40, v41
    v_mov_b32 v42, v40
    s_nop 1
    v_permlane16_swap_b32 v40, v42
    v_add_f32 v40, v40, v42
    s_nop 1
    v_add_f32_dpp v40, v40, v40 row_ror:8 row_mask:0xf bank_mask:0xf
    s_mov_b64 exec, s[48:49]
    ds_write_b32 v10, v40 offset:0
    s_mov_b64 exec, -1
    s_waitcnt lgkmcnt(0)
    s_barrier
    ds_read_b128 v[48:51], v11 offset:0
    ds_read_b128 v[52:55], v11 offset:16
    ds_read_b128 v[56:59], v11 offset:256
    ds_read_b128 v[60:63], v11 offset:272
    s_waitcnt lgkmcnt(2)
    v_add_f32 v48, v48, v49
    v_add_f32 v50, v50, v51
    v_add_f32 v52, v52, v53
    v_add_f32 v54, v54, v55
    v_add_f32 v48, v48, v50
    v_add_f32 v52, v52, v54
    v_add_f32 v48, v48, v52
    s_waitcnt lgkmcnt(0)
    v_add_f32 v56, v56, v57
    v_add_f32 v58, v58, v59
    v_add_f32 v60, v60, v61
    v_add_f32 v62, v62, v63
    v_add_f32 v56, v56, v58
    v_add_f32 v60, v60, v62
    v_add_f32 v56, v56, v60
    v_mul_f32 v48, 0x3b000000, v48
    v_mul_f32 v49, 0x3b000000, v56
    v_add_f32 v21, v20, v48
    v_fma_f32 v49, -v48, v48, v49
    v_max_f32 v49, 0, v49
    v_cvt_pk_bf16_f32 v50, v21, v49
    v_lshlrev_b32 v22, 16, v50
    v_and_b32 v49, 0xffff0000, v50
    v_add_f32 v49, 0x3727c5ac, v49
    v_cvt_pk_bf16_f32 v49, v49, v49
    v_and_b32 v49, 0xffff0000, v49
    v_sqrt_f32 v49, v49
    s_nop 0
    v_cvt_pk_bf16_f32 v49, v49, v49
    v_and_b32 v23, 0xffff0000, v49
    v_rcp_f32 v36, v23
    s_waitcnt vmcnt(0)
    v_sub_f32 v51, v24, v22
    v_sub_f32 v52, v25, v22
    v_cvt_pk_bf16_f32 v53, v51, v52
    v_lshlrev_b32 v51, 16, v53
    v_and_b32 v52, 0xffff0000, v53
    v_mul_f32 v54, v51, v36
    v_fma_f32 v55, -v54, v23, v51
    v_fma_f32 v51, v55, v36, v54
    v_mul_f32 v54, v52, v36
    v_fma_f32 v55, -v54, v23, v52
    v_fma_f32 v52, v55, v36, v54
    v_cvt_pk_bf16_f32 v53, v51, v52
    v_lshlrev_b32 v51, 16, v53
    v_and_b32 v52, 0xffff0000, v53
    v_lshlrev_b32 v54, 16, v12
    v_and_b32 v55, 0xffff0000, v12
    v_mul_f32 v51, v51, v54
    v_mul_f32 v52, v52, v55
    v_cvt_pk_bf16_f32 v53, v51, v52
    v_lshlrev_b32 v51, 16, v53
    v_and_b32 v52, 0xffff0000, v53
    v_add_f32 v51, v51, v24
    v_add_f32 v52, v52, v25
    v_cvt_pk_bf16_f32 v56, v51, v52
    v_lshlrev_b32 v24, 16, v56
    v_and_b32 v25, 0xffff0000, v56
    v_sub_f32 v51, v26, v22
    v_sub_f32 v52, v27, v22
    v_cvt_pk_bf16_f32 v53, v51, v52
    v_lshlrev_b32 v51, 16, v53
    v_and_b32 v52, 0xffff0000, v53
    v_mul_f32 v54, v51, v36
    v_fma_f32 v55, -v54, v23, v51
    v_fma_f32 v51, v55, v36, v54
    v_mul_f32 v54, v52, v36
    v_fma_f32 v55, -v54, v23, v52
    v_fma_f32 v52, v55, v36, v54
    v_cvt_pk_bf16_f32 v53, v51, v52
    v_lshlrev_b32 v51, 16, v53
    v_and_b32 v52, 0xffff0000, v53
    v_lshlrev_b32 v54, 16, v13
    v_and_b32 v55, 0xffff0000, v13
    v_mul_f32 v51, v51, v54
    v_mul_f32 v52, v52, v55
    v_cvt_pk_bf16_f32 v53, v51, v52
    v_lshlrev_b32 v51, 16, v53
    v_and_b32 v52, 0xffff0000, v53
    v_add_f32 v51, v51, v26
    v_add_f32 v52, v52, v27
    v_cvt_pk_bf16_f32 v57, v51, v52
    v_lshlrev_b32 v26, 16, v57
    v_and_b32 v27, 0xffff0000, v57
    v_sub_f32 v51, v28, v22
    v_sub_f32 v52, v29, v22
    v_cvt_pk_bf16_f32 v53, v51, v52
    v_lshlrev_b32 v51, 16, v53
    v_and_b32 v52, 0xffff0000, v53
    v_mul_f32 v54, v51, v36
    v_fma_f32 v55, -v54, v23, v51
    v_fma_f32 v51, v55, v36, v54
    v_mul_f32 v54, v52, v36
    v_fma_f32 v55, -v54, v23, v52
    v_fma_f32 v52, v55, v36, v54
    v_cvt_pk_bf16_f32 v53, v51, v52
    v_lshlrev_b32 v51, 16, v53
    v_and_b32 v52, 0xffff0000, v53
    v_lshlrev_b32 v54, 16, v14
    v_and_b32 v55, 0xffff0000, v14
    v_mul_f32 v51, v51, v54
    v_mul_f32 v52, v52, v55
    v_cvt_pk_bf16_f32 v53, v51, v52
    v_lshlrev_b32 v51, 16, v53
    v_and_b32 v52, 0xffff0000, v53
    v_add_f32 v51, v51, v28
    v_add_f32 v52, v52, v29
    v_cvt_pk_bf16_f32 v58, v51, v52
    v_lshlrev_b32 v28, 16, v58
    v_and_b32 v29, 0xffff0000, v58
    v_sub_f32 v51, v30, v22
    v_sub_f32 v52, v31, v22
    v_cvt_pk_bf16_f32 v53, v51, v52
    v_lshlrev_b32 v51, 16, v53
    v_and_b32 v52, 0xffff0000, v53
    v_mul_f32 v54, v51, v36
    v_fma_f32 v55, -v54, v23, v51
    v_fma_f32 v51, v55, v36, v54
    v_mul_f32 v54, v52, v36
    v_fma_f32 v55, -v54, v23, v52
    v_fma_f32 v52, v55, v36, v54
    v_cvt_pk_bf16_f32 v53, v51, v52
    v_lshlrev_b32 v51, 16, v53
    v_and_b32 v52, 0xffff0000, v53
    v_lshlrev_b32 v54, 16, v15
    v_and_b32 v55, 0xffff0000, v15
    v_mul_f32 v51, v51, v54
    v_mul_f32 v52, v52, v55
    v_cvt_pk_bf16_f32 v53, v51, v52
    v_lshlrev_b32 v51, 16, v53
    v_and_b32 v52, 0xffff0000, v53
    v_add_f32 v51, v51, v30
    v_add_f32 v52, v52, v31
    v_cvt_pk_bf16_f32 v59, v51, v52
    v_lshlrev_b32 v30, 16, v59
    v_and_b32 v31, 0xffff0000, v59
    s_mov_b32 s34, 8388608
    buffer_store_dword v56, v8, s[28:31], s34 offen
    s_mov_b32 s34, 8396800
    buffer_store_dword v57, v8, s[28:31], s34 offen
    s_mov_b32 s34, 8404992
    buffer_store_dword v58, v8, s[28:31], s34 offen
    s_mov_b32 s34, 8413184
    buffer_store_dword v59, v8, s[28:31], s34 offen
    v_sub_f32 v48, v24, v21
    v_sub_f32 v49, v25, v21
    v_sub_f32 v50, v26, v21
    v_sub_f32 v51, v27, v21
    v_sub_f32 v52, v28, v21
    v_sub_f32 v53, v29, v21
    v_sub_f32 v54, v30, v21
    v_sub_f32 v55, v31, v21
    v_add_f32 v40, v48, v49
    v_mul_f32 v41, v48, v48
    v_mul_f32 v42, v49, v49
    v_add_f32 v43, v50, v51
    v_fmac_f32 v41, v50, v50
    v_fmac_f32 v42, v51, v51
    v_add_f32 v40, v40, v43
    v_add_f32 v43, v52, v53
    v_fmac_f32 v41, v52, v52
    v_fmac_f32 v42, v53, v53
    v_add_f32 v40, v40, v43
    v_add_f32 v43, v54, v55
    v_fmac_f32 v41, v54, v54
    v_fmac_f32 v42, v55, v55
    v_add_f32 v40, v40, v43
    v_add_f32 v41, v41, v42
    s_nop 1
    v_permlane32_swap_b32 v40, v41
    v_add_f32 v40, v40, v41
    v_mov_b32 v42, v40
    s_nop 1
    v_permlane16_swap_b32 v40, v42
    v_add_f32 v40, v40, v42
    s_nop 1
    v_add_f32_dpp v40, v40, v40 row_ror:8 row_mask:0xf bank_mask:0xf
    s_mov_b64 exec, s[48:49]
    ds_write_b32 v10, v40 offset:512
    s_mov_b64 exec, -1
    s_waitcnt lgkmcnt(0)
    s_barrier
    v_cmp_gt_u32 vcc, 8, v0
    s_nop 0
    s_and_saveexec_b64 s[36:37], vcc
    s_cbranch_execz L_row2_kernel_end
    ds_read_b128 v[64:67], v11 offset:512
    ds_read_b128 v[68:71], v11 offset:528
    ds_read_b128 v[72:75], v11 offset:768
    ds_read_b128 v[76:79], v11 offset:784
    s_waitcnt lgkmcnt(2)
    v_add_f32 v64, v64, v65
    v_add_f32 v66, v66, v67
    v_add_f32 v68, v68, v69
    v_add_f32 v70, v70, v71
    v_add_f32 v64, v64, v66
    v_add_f32 v68, v68, v70
    v_add_f32 v64, v64, v68
    s_waitcnt lgkmcnt(0)
    v_add_f32 v72, v72, v73
    v_add_f32 v74, v74, v75
    v_add_f32 v76, v76, v77
    v_add_f32 v78, v78, v79
    v_add_f32 v72, v72, v74
    v_add_f32 v76, v76, v78
    v_add_f32 v72, v72, v76
    v_mul_f32 v64, 0x3b000000, v64
    v_mul_f32 v65, 0x3b000000, v72
    v_add_f32 v60, v21, v64
    v_fma_f32 v65, -v64, v64, v65
    v_max_f32 v65, 0, v65
    v_cvt_pk_bf16_f32 v66, v60, v65
    v_lshlrev_b32 v61, 16, v66
    v_and_b32 v65, 0xffff0000, v66
    v_add_f32 v65, 0x3727c5ac, v65
    v_cvt_pk_bf16_f32 v65, v65, v65
    v_and_b32 v65, 0xffff0000, v65
    v_sqrt_f32 v65, v65
    s_nop 0
    v_cvt_pk_bf16_f32 v65, v65, v65
    v_and_b32 v62, 0xffff0000, v65
    v_lshrrev_b32 v61, 16, v61
    v_or_b32 v61, v61, v62
    v_lshlrev_b32 v7, 2, v3
    s_mov_b32 s35, 10551296
    buffer_store_dword v61, v7, s[28:31], s35 offen
    s_endpgm
L_row2_kernel_end_kgen:
    s_cmp_ge_u32 s2, 256
    s_cbranch_scc1 L_row2_kernel_end
L_row2_kernel_end:
    s_endpgm

.globl convB2_kernel
.p2align 8
.type convB2_kernel,@function
convB2_kernel:
    s_cmp_ge_u32 s2, 256
    s_cbranch_scc1 L_convB2_kernel_end
    s_load_dwordx2 s[10:11], s[0:1], 120
    s_load_dwordx4 s[4:7], s[0:1], 96
    s_and_b32 s3, s2, 7
    s_lshl_b32 s3, s3, 5
    s_lshr_b32 s12, s2, 3
    s_add_u32 s3, s3, s12
    v_lshrrev_b32 v1, 6, v0
    v_and_b32 v2, 63, v0
    v_lshlrev_b32 v14, 4, v0
    v_readfirstlane_b32 s14, v1
    s_lshl_b32 s13, s3, 13
    s_lshl_b32 s15, s3, 2
    s_waitcnt lgkmcnt(0)
    s_mov_b32 s28, s10
    s_and_b32 s29, s11, 0xffff
    s_mov_b32 s30, 268435456
    s_mov_b32 s31, 0x00020000
    s_add_u32 s32, s13, 8388608
    buffer_load_dwordx4 v[4:7], v14, s[28:31], s32 offen
    s_mov_b32 s34, 10551296
    buffer_load_dwordx4 v[48:51], v14, s[28:31], s34 offen
    s_lshl_b32 s35, s3, 13
    s_add_u32 s35, s35, 12582912
    buffer_load_dwordx4 v[52:55], v14, s[28:31], s35 offen
    s_add_u32 s4, s4, s15
    s_addc_u32 s5, s5, 0
    s_load_dword s33, s[4:5], 0
    s_mov_b32 s20, s6
    s_and_b32 s21, s7, 0xffff
    s_mov_b32 s22, 2097152
    s_mov_b32 s23, 0x00020000
    v_mov_b32 v64, 0
    v_mov_b32 v65, 0
    v_mov_b32 v66, 0
    v_mov_b32 v67, 0
    v_lshrrev_b32 v61, 4, v0
    v_mul_u32_u24 v61, 1152, v61
    v_and_b32 v62, 15, v0
    v_lshl_add_u32 v61, v62, 3, v61
    v_cmp_gt_u32 vcc, 128, v0
    s_nop 0
    s_and_saveexec_b64 s[36:37], vcc
    ds_write_b64 v61, v[64:65] offset:8320
    ds_write_b64 v61, v[64:65] offset:17672
    s_mov_b64 exec, s[36:37]
    v_lshrrev_b32 v61, 1, v0
    v_mul_u32_u24 v61, 4160, v61
    v_and_b32 v62, 1, v0
    v_lshl_add_u32 v61, v62, 4, v61
    v_cmp_gt_u32 vcc, 4, v0
    s_nop 0
    s_and_saveexec_b64 s[36:37], vcc
    ds_write_b128 v61, v[64:67] offset:0
    s_mov_b64 exec, s[36:37]
    s_mov_b32 s38, 0x05040100
    s_mov_b32 s39, 0x07060302
    s_lshr_b32 s40, s14, 2
    s_and_b32 s41, s14, 3
    s_mul_i32 s42, s40, 4160
    s_add_u32 s42, s42, 32
    s_mul_i32 s43, s40, 4
    s_add_u32 s43, s43, s41
    s_mul_i32 s43, s43, 1152
    s_add_u32 s43, s43, 8376
    v_lshrrev_b32 v70, 4, v2
    v_and_b32 v71, 3, v2
    v_bfe_u32 v72, v2, 2, 2
    v_sub_u32 v71, v71, v72
    v_lshlrev_b32 v71, 3, v71
    v_lshl_add_u32 v71, v70, 6, v71
    v_add_u32 v12, s42, v71
    v_and_b32 v71, 15, v2
    v_lshlrev_b32 v71, 3, v71
    v_lshlrev_b32 v72, 4, v70
    v_sub_u32 v71, v71, v72
    v_add_u32 v13, s43, v71
    v_and_b32 v71, 1, v2
    v_xor_b32 v71, 1, v71
    v_mul_u32_u24 v71, 9352, v71
    v_add_u32 v13, v13, v71
    v_mov_b32 v16, 0
    v_mov_b32 v17, 0
    v_mov_b32 v18, 0
    v_mov_b32 v19, 0
    v_mov_b32 v20, 0
    v_mov_b32 v21, 0
    v_mov_b32 v22, 0
    v_mov_b32 v23, 0
    v_mov_b32 v24, 0
    v_mov_b32 v25, 0
    v_mov_b32 v26, 0
    v_mov_b32 v27, 0
    v_mov_b32 v28, 0
    v_mov_b32 v29, 0
    v_mov_b32 v30, 0
    v_mov_b32 v31, 0
    v_mov_b32 v32, 0
    v_mov_b32 v33, 0
    v_mov_b32 v34, 0
    v_mov_b32 v35, 0
    v_mov_b32 v36, 0
    v_mov_b32 v37, 0
    v_mov_b32 v38, 0
    v_mov_b32 v39, 0
    v_mov_b32 v40, 0
    v_mov_b32 v41, 0
    v_mov_b32 v42, 0
    v_mov_b32 v43, 0
    v_mov_b32 v44, 0
    v_mov_b32 v45, 0
    v_mov_b32 v46, 0
    v_mov_b32 v47, 0
    v_and_b32 v70, 15, v2
    v_lshrrev_b32 v71, 4, v2
    v_lshlrev_b32 v72, 2, v71
    v_xor_b32 v70, v70, v72
    v_lshl_add_u32 v70, v71, 4, v70
    v_lshlrev_b32 v70, 4, v70
    s_mul_i32 s44, s14, 8208
    s_add_u32 s44, s44, 27136
    v_add_u32 v176, s44, v70
    v_mov_b32 v70, s44
    s_mov_b64 exec, 1
    ds_write_b128 v70, v[64:67] offset:8192
    s_mov_b64 exec, -1
    v_lshrrev_b32 v70, 2, v2
    v_and_b32 v71, 3, v2
    v_lshlrev_b32 v72, 2, v71
    v_xor_b32 v70, v70, v72
    v_lshl_add_u32 v70, v71, 4, v70
    v_lshlrev_b32 v70, 4, v70
    s_lshl_b32 s44, s14, 10
    s_add_u32 s44, s44, 27136
    v_add_u32 v177, s44, v70
    v_subrev_u32 v73, 1, v2
    v_lshrrev_b32 v71, 2, v73
    v_and_b32 v73, 3, v73
    v_lshlrev_b32 v72, 2, v73
    v_xor_b32 v71, v71, v72
    v_lshl_add_u32 v71, v73, 4, v71
    v_lshlrev_b32 v71, 4, v71
    v_add_u32 v71, s44, v71
    s_sub_u32 s45, s44, 208
    s_cmp_eq_u32 s14, 0
    s_cselect_b32 s45, 35328, s45
    v_mov_b32 v72, s45
    v_cmp_eq_u32 vcc, 0, v2
    s_nop 1
    v_cndmask_b32 v178, v71, v72, vcc
    v_add_u32 v179, 32832, v177
    v_add_u32 v180, 32832, v178
    v_lshlrev_b32 v62, 3, v0
    v_mul_u32_u24 v61, 1152, v1
    v_lshl_add_u32 v61, v2, 4, v61
    s_waitcnt vmcnt(1)
    v_lshlrev_b32 v72, 16, v48
    v_and_b32 v73, 0xffff0000, v48
    v_rcp_f32 v74, v73
    v_lshlrev_b32 v192, 16, v4
    v_and_b32 v193, 0xffff0000, v4
    v_lshlrev_b32 v80, 16, v49
    v_and_b32 v81, 0xffff0000, v49
    v_rcp_f32 v82, v81
    v_lshlrev_b32 v194, 16, v5
    v_and_b32 v195, 0xffff0000, v5
    v_lshlrev_b32 v88, 16, v50
    v_and_b32 v89, 0xffff0000, v50
    v_rcp_f32 v90, v89
    v_lshlrev_b32 v196, 16, v6
    v_and_b32 v197, 0xffff0000, v6
    v_lshlrev_b32 v96, 16, v51
    v_and_b32 v97, 0xffff0000, v51
    v_rcp_f32 v98, v97
    v_lshlrev_b32 v198, 16, v7
    v_and_b32 v199, 0xffff0000, v7
    v_sub_f32 v75, v192, v72
    v_sub_f32 v76, v193, v72
    v_cvt_pk_bf16_f32 v77, v75, v76
    v_lshlrev_b32 v75, 16, v77
    v_and_b32 v76, 0xffff0000, v77
    v_mul_f32 v78, v75, v74
    v_fma_f32 v79, -v78, v73, v75
    v_fma_f32 v75, v79, v74, v78
    v_mul_f32 v78, v76, v74
    v_fma_f32 v79, -v78, v73, v76
    v_fma_f32 v76, v79, v74, v78
    v_cvt_pk_bf16_f32 v8, v75, v76
    v_sub_f32 v83, v194, v80
    v_sub_f32 v84, v195, v80
    v_cvt_pk_bf16_f32 v85, v83, v84
    v_lshlrev_b32 v83, 16, v85
    v_and_b32 v84, 0xffff0000, v85
    v_mul_f32 v86, v83, v82
    v_fma_f32 v87, -v86, v81, v83
    v_fma_f32 v83, v87, v82, v86
    v_mul_f32 v86, v84, v82
    v_fma_f32 v87, -v86, v81, v84
    v_fma_f32 v84, v87, v82, v86
    v_cvt_pk_bf16_f32 v9, v83, v84
    v_sub_f32 v91, v196, v88
    v_sub_f32 v92, v197, v88
    v_cvt_pk_bf16_f32 v93, v91, v92
    v_lshlrev_b32 v91, 16, v93
    v_and_b32 v92, 0xffff0000, v93
    v_mul_f32 v94, v91, v90
    v_fma_f32 v95, -v94, v89, v91
    v_fma_f32 v91, v95, v90, v94
    v_mul_f32 v94, v92, v90
    v_fma_f32 v95, -v94, v89, v92
    v_fma_f32 v92, v95, v90, v94
    v_cvt_pk_bf16_f32 v10, v91, v92
    v_sub_f32 v99, v198, v96
    v_sub_f32 v100, v199, v96
    v_cvt_pk_bf16_f32 v101, v99, v100
    v_lshlrev_b32 v99, 16, v101
    v_and_b32 v100, 0xffff0000, v101
    v_mul_f32 v102, v99, v98
    v_fma_f32 v103, -v102, v97, v99
    v_fma_f32 v99, v103, v98, v102
    v_mul_f32 v102, v100, v98
    v_fma_f32 v103, -v102, v97, v100
    v_fma_f32 v100, v103, v98, v102
    v_cvt_pk_bf16_f32 v11, v99, v100
    v_perm_b32 v64, v9, v8, s38
    v_perm_b32 v65, v11, v10, s38
    v_perm_b32 v66, v9, v8, s39
    v_perm_b32 v67, v11, v10, s39
    ds_write_b64 v62, v[64:65] offset:32
    ds_write_b64 v62, v[66:67] offset:4192
    s_waitcnt vmcnt(0)
    ds_write_b128 v61, v[52:55] offset:8448
    ds_write_b64 v61, v[52:53] offset:17800
    ds_write_b64 v61, v[54:55] offset:17808
    s_waitcnt lgkmcnt(0)
    s_lshl_b32 s46, s33, 16
    s_and_b32 s47, s33, 0xffff0000
    s_barrier
    ds_read_b64_tr_b16 v[48:49], v12 offset:32
    ds_read_b64_tr_b16 v[50:51], v12 offset:0
    ds_read_b128 v[80:83], v13 offset:64
    ds_read_b128 v[84:87], v13 offset:192
    ds_read_b64_tr_b16 v[52:53], v12 offset:544
    ds_read_b64_tr_b16 v[54:55], v12 offset:512
    ds_read_b128 v[88:91], v13 offset:320
    ds_read_b64_tr_b16 v[56:57], v12 offset:1056
    ds_read_b64_tr_b16 v[58:59], v12 offset:1024
    ds_read_b128 v[92:95], v13 offset:448
    ds_read_b64_tr_b16 v[60:61], v12 offset:1568
    ds_read_b64_tr_b16 v[62:63], v12 offset:1536
    ds_read_b128 v[96:99], v13 offset:576
    ds_read_b64_tr_b16 v[64:65], v12 offset:2080
    ds_read_b64_tr_b16 v[66:67], v12 offset:2048
    ds_read_b128 v[100:103], v13 offset:704
    ds_read_b64_tr_b16 v[68:69], v12 offset:2592
    ds_read_b64_tr_b16 v[70:71], v12 offset:2560
    ds_read_b128 v[104:107], v13 offset:832
    ds_read_b64_tr_b16 v[72:73], v12 offset:3104
    ds_read_b64_tr_b16 v[74:75], v12 offset:3072
    ds_read_b128 v[108:111], v13 offset:960
    ds_read_b64_tr_b16 v[76:77], v12 offset:3616
    ds_read_b64_tr_b16 v[78:79], v12 offset:3584
    s_waitcnt lgkmcnt(15)
    v_mfma_f32_16x16x32_bf16 v[16:19], v[48:51], v[80:83], v[16:19]
    ds_read_b64_tr_b16 v[112:113], v12 offset:288
    v_mfma_f32_16x16x32_bf16 v[20:23], v[48:51], v[84:87], v[20:23]
    ds_read_b64_tr_b16 v[114:115], v12 offset:256
    v_mfma_f32_16x16x32_bf16 v[20:23], v[52:55], v[80:83], v[20:23]
    ds_read_b128 v[144:147], v13 offset:0
    v_mfma_f32_16x16x32_bf16 v[24:27], v[48:51], v[88:91], v[24:27]
    ds_read_b128 v[148:151], v13 offset:128
    v_mfma_f32_16x16x32_bf16 v[24:27], v[52:55], v[84:87], v[24:27]
    ds_read_b64_tr_b16 v[116:117], v12 offset:800
    v_mfma_f32_16x16x32_bf16 v[24:27], v[56:59], v[80:83], v[24:27]
    ds_read_b64_tr_b16 v[118:119], v12 offset:768
    s_waitcnt lgkmcnt(15)
    v_mfma_f32_16x16x32_bf16 v[28:31], v[48:51], v[92:95], v[28:31]
    ds_read_b128 v[152:155], v13 offset:256
    v_mfma_f32_16x16x32_bf16 v[28:31], v[52:55], v[88:91], v[28:31]
    ds_read_b64_tr_b16 v[120:121], v12 offset:1312
    v_mfma_f32_16x16x32_bf16 v[28:31], v[56:59], v[84:87], v[28:31]
    ds_read_b64_tr_b16 v[122:123], v12 offset:1280
    v_mfma_f32_16x16x32_bf16 v[28:31], v[60:63], v[80:83], v[28:31]
    ds_read_b128 v[156:159], v13 offset:384
    v_mfma_f32_16x16x32_bf16 v[32:35], v[48:51], v[96:99], v[32:35]
    ds_read_b64_tr_b16 v[124:125], v12 offset:1824
    v_mfma_f32_16x16x32_bf16 v[32:35], v[52:55], v[92:95], v[32:35]
    ds_read_b64_tr_b16 v[126:127], v12 offset:1792
    v_mfma_f32_16x16x32_bf16 v[32:35], v[56:59], v[88:91], v[32:35]
    ds_read_b128 v[160:163], v13 offset:512
    v_mfma_f32_16x16x32_bf16 v[32:35], v[60:63], v[84:87], v[32:35]
    ds_read_b64_tr_b16 v[128:129], v12 offset:2336
    v_mfma_f32_16x16x32_bf16 v[32:35], v[64:67], v[80:83], v[32:35]
    ds_read_b64_tr_b16 v[130:131], v12 offset:2304
    s_waitcnt lgkmcnt(15)
    v_mfma_f32_16x16x32_bf16 v[36:39], v[48:51], v[100:103], v[36:39]
    ds_read_b128 v[164:167], v13 offset:640
    v_mfma_f32_16x16x32_bf16 v[36:39], v[52:55], v[96:99], v[36:39]
    ds_read_b64_tr_b16 v[132:133], v12 offset:2848
    v_mfma_f32_16x16x32_bf16 v[36:39], v[56:59], v[92:95], v[36:39]
    ds_read_b64_tr_b16 v[134:135], v12 offset:2816
    v_mfma_f32_16x16x32_bf16 v[36:39], v[60:63], v[88:91], v[36:39]
    ds_read_b128 v[168:171], v13 offset:768
    v_mfma_f32_16x16x32_bf16 v[36:39], v[64:67], v[84:87], v[36:39]
    ds_read_b64_tr_b16 v[136:137], v12 offset:3360
    v_mfma_f32_16x16x32_bf16 v[36:39], v[68:71], v[80:83], v[36:39]
    ds_read_b64_tr_b16 v[138:139], v12 offset:3328
    v_mfma_f32_16x16x32_bf16 v[40:43], v[48:51], v[104:107], v[40:43]
    ds_read_b128 v[172:175], v13 offset:896
    v_mfma_f32_16x16x32_bf16 v[40:43], v[52:55], v[100:103], v[40:43]
    ds_read_b64_tr_b16 v[140:141], v12 offset:3872
    v_mfma_f32_16x16x32_bf16 v[40:43], v[56:59], v[96:99], v[40:43]
    ds_read_b64_tr_b16 v[142:143], v12 offset:3840
    v_mfma_f32_16x16x32_bf16 v[40:43], v[60:63], v[92:95], v[40:43]
    v_lshlrev_b32 v184, 16, v8
    v_mfma_f32_16x16x32_bf16 v[40:43], v[64:67], v[88:91], v[40:43]
    v_and_b32 v185, 0xffff0000, v8
    v_mfma_f32_16x16x32_bf16 v[40:43], v[68:71], v[84:87], v[40:43]
    v_mul_f32 v184, s46, v184
    v_mfma_f32_16x16x32_bf16 v[40:43], v[72:75], v[80:83], v[40:43]
    v_mul_f32 v185, s47, v185
    v_mfma_f32_16x16x32_bf16 v[44:47], v[48:51], v[108:111], v[44:47]
    v_cvt_pk_bf16_f32 v15, v184, v185
    v_mfma_f32_16x16x32_bf16 v[44:47], v[52:55], v[104:107], v[44:47]
    v_lshlrev_b32 v184, 16, v15
    v_mfma_f32_16x16x32_bf16 v[44:47], v[56:59], v[100:103], v[44:47]
    v_and_b32 v185, 0xffff0000, v15
    v_mfma_f32_16x16x32_bf16 v[44:47], v[60:63], v[96:99], v[44:47]
    v_lshlrev_b32 v186, 16, v9
    v_mfma_f32_16x16x32_bf16 v[44:47], v[64:67], v[92:95], v[44:47]
    v_and_b32 v187, 0xffff0000, v9
    v_mfma_f32_16x16x32_bf16 v[44:47], v[68:71], v[88:91], v[44:47]
    v_mul_f32 v186, s46, v186
    v_mfma_f32_16x16x32_bf16 v[44:47], v[72:75], v[84:87], v[44:47]
    v_mul_f32 v187, s47, v187
    v_mfma_f32_16x16x32_bf16 v[44:47], v[76:79], v[80:83], v[44:47]
    v_cvt_pk_bf16_f32 v15, v186, v187
    s_waitcnt lgkmcnt(15)
    v_mfma_f32_16x16x32_bf16 v[16:19], v[112:115], v[144:147], v[16:19]
    v_lshlrev_b32 v186, 16, v15
    v_mfma_f32_16x16x32_bf16 v[20:23], v[112:115], v[148:151], v[20:23]
    v_and_b32 v187, 0xffff0000, v15
    v_mfma_f32_16x16x32_bf16 v[20:23], v[116:119], v[144:147], v[20:23]
    v_lshlrev_b32 v188, 16, v10
    v_mfma_f32_16x16x32_bf16 v[24:27], v[112:115], v[152:155], v[24:27]
    v_and_b32 v189, 0xffff0000, v10
    v_mfma_f32_16x16x32_bf16 v[24:27], v[116:119], v[148:151], v[24:27]
    v_mul_f32 v188, s46, v188
    v_mfma_f32_16x16x32_bf16 v[24:27], v[120:123], v[144:147], v[24:27]
    v_mul_f32 v189, s47, v189
    ds_write_b128 v176, v[16:19] offset:0
    s_waitcnt lgkmcnt(15)
    v_mfma_f32_16x16x32_bf16 v[28:31], v[112:115], v[156:159], v[28:31]
    v_cvt_pk_bf16_f32 v15, v188, v189
    v_mfma_f32_16x16x32_bf16 v[28:31], v[116:119], v[152:155], v[28:31]
    v_lshlrev_b32 v188, 16, v15
    ds_write_b128 v176, v[20:23] offset:1024
    v_mfma_f32_16x16x32_bf16 v[28:31], v[120:123], v[148:151], v[28:31]
    v_and_b32 v189, 0xffff0000, v15
    s_waitcnt lgkmcnt(14)
    v_mfma_f32_16x16x32_bf16 v[28:31], v[124:127], v[144:147], v[28:31]
    v_lshlrev_b32 v190, 16, v11
    s_waitcnt lgkmcnt(13)
    v_mfma_f32_16x16x32_bf16 v[32:35], v[112:115], v[160:163], v[32:35]
    v_and_b32 v191, 0xffff0000, v11
    ds_write_b128 v176, v[24:27] offset:2048
    v_mfma_f32_16x16x32_bf16 v[32:35], v[116:119], v[156:159], v[32:35]
    v_mul_f32 v190, s46, v190
    v_mfma_f32_16x16x32_bf16 v[32:35], v[120:123], v[152:155], v[32:35]
    v_mul_f32 v191, s47, v191
    v_mfma_f32_16x16x32_bf16 v[32:35], v[124:127], v[148:151], v[32:35]
    v_cvt_pk_bf16_f32 v15, v190, v191
    s_waitcnt lgkmcnt(12)
    v_mfma_f32_16x16x32_bf16 v[32:35], v[128:131], v[144:147], v[32:35]
    v_lshlrev_b32 v190, 16, v15
    ds_write_b128 v176, v[28:31] offset:3072
    s_waitcnt lgkmcnt(12)
    v_mfma_f32_16x16x32_bf16 v[36:39], v[112:115], v[164:167], v[36:39]
    v_and_b32 v191, 0xffff0000, v15
    v_mfma_f32_16x16x32_bf16 v[36:39], v[116:119], v[160:163], v[36:39]
    v_lshlrev_b32 v3, 12, v0
    v_mfma_f32_16x16x32_bf16 v[36:39], v[120:123], v[156:159], v[36:39]
    v_mfma_f32_16x16x32_bf16 v[36:39], v[124:127], v[152:155], v[36:39]
    v_mfma_f32_16x16x32_bf16 v[36:39], v[128:131], v[148:151], v[36:39]
    ds_write_b128 v176, v[32:35] offset:4096
    s_waitcnt lgkmcnt(11)
    v_mfma_f32_16x16x32_bf16 v[36:39], v[132:135], v[144:147], v[36:39]
    s_waitcnt lgkmcnt(10)
    v_mfma_f32_16x16x32_bf16 v[40:43], v[112:115], v[168:171], v[40:43]
    v_mfma_f32_16x16x32_bf16 v[40:43], v[116:119], v[164:167], v[40:43]
    v_mfma_f32_16x16x32_bf16 v[40:43], v[120:123], v[160:163], v[40:43]
    v_mfma_f32_16x16x32_bf16 v[40:43], v[124:127], v[156:159], v[40:43]
    v_mfma_f32_16x16x32_bf16 v[40:43], v[128:131], v[152:155], v[40:43]
    s_nop 1
    ds_write_b128 v176, v[36:39] offset:5120
    v_mfma_f32_16x16x32_bf16 v[40:43], v[132:135], v[148:151], v[40:43]
    s_waitcnt lgkmcnt(9)
    v_mfma_f32_16x16x32_bf16 v[40:43], v[136:139], v[144:147], v[40:43]
    s_waitcnt lgkmcnt(8)
    v_mfma_f32_16x16x32_bf16 v[44:47], v[112:115], v[172:175], v[44:47]
    v_mfma_f32_16x16x32_bf16 v[44:47], v[116:119], v[168:171], v[44:47]
    v_mfma_f32_16x16x32_bf16 v[44:47], v[120:123], v[164:167], v[44:47]
    v_mfma_f32_16x16x32_bf16 v[44:47], v[124:127], v[160:163], v[44:47]
    v_mfma_f32_16x16x32_bf16 v[44:47], v[128:131], v[156:159], v[44:47]
    s_nop 1
    ds_write_b128 v176, v[40:43] offset:6144
    v_mfma_f32_16x16x32_bf16 v[44:47], v[132:135], v[152:155], v[44:47]
    v_mfma_f32_16x16x32_bf16 v[44:47], v[136:139], v[148:151], v[44:47]
    s_waitcnt lgkmcnt(7)
    v_mfma_f32_16x16x32_bf16 v[44:47], v[140:143], v[144:147], v[44:47]
    s_nop 7
    ds_write_b128 v176, v[44:47] offset:7168
    s_waitcnt lgkmcnt(0)
    s_barrier
    ds_read_b128 v[48:51], v177 offset:0
    ds_read_b128 v[52:55], v177 offset:8208
    ds_read_b128 v[84:87], v178 offset:8208
    ds_read_b128 v[56:59], v177 offset:16416
    ds_read_b128 v[88:91], v178 offset:16416
    ds_read_b128 v[60:63], v177 offset:24624
    ds_read_b128 v[92:95], v178 offset:24624
    ds_read_b128 v[64:67], v179 offset:0
    ds_read_b128 v[68:71], v179 offset:8208
    ds_read_b128 v[100:103], v180 offset:8208
    ds_read_b128 v[72:75], v179 offset:16416
    ds_read_b128 v[104:107], v180 offset:16416
    ds_read_b128 v[76:79], v179 offset:24624
    ds_read_b128 v[108:111], v180 offset:24624
    s_waitcnt lgkmcnt(7)
    v_add_f32 v16, v48, v87
    v_add_f32 v24, v90, v93
    v_add_f32 v16, v16, v24
    v_add_f32 v17, v49, v52
    v_add_f32 v25, v91, v94
    v_add_f32 v17, v17, v25
    v_add_f32 v18, v50, v53
    v_add_f32 v26, v56, v95
    v_add_f32 v18, v18, v26
    v_add_f32 v19, v51, v54
    v_add_f32 v27, v57, v60
    v_add_f32 v19, v19, v27
    s_waitcnt lgkmcnt(0)
    v_add_f32 v20, v64, v103
    v_add_f32 v24, v106, v109
    v_add_f32 v20, v20, v24
    v_add_f32 v21, v65, v68
    v_add_f32 v25, v107, v110
    v_add_f32 v21, v21, v25
    v_add_f32 v22, v66, v69
    v_add_f32 v26, v72, v111
    v_add_f32 v22, v22, v26
    v_add_f32 v23, v67, v70
    v_add_f32 v27, v73, v76
    v_add_f32 v23, v23, v27
    v_cvt_pk_bf16_f32 v28, v16, v20
    v_lshlrev_b32 v29, 16, v28
    v_and_b32 v30, 0xffff0000, v28
    v_add_f32 v29, v29, v184
    v_add_f32 v30, v30, v185
    v_cvt_pk_bf16_f32 v28, v29, v30
    v_lshlrev_b32 v29, 16, v28
    v_and_b32 v30, 0xffff0000, v28
    v_add_f32 v29, v29, v192
    v_add_f32 v30, v30, v193
    v_cvt_pk_bf16_f32 v44, v29, v30
    buffer_store_dword v44, v3, s[20:23], s15 offen offset:0
    v_cvt_pk_bf16_f32 v32, v17, v21
    v_lshlrev_b32 v33, 16, v32
    v_and_b32 v34, 0xffff0000, v32
    v_add_f32 v33, v33, v186
    v_add_f32 v34, v34, v187
    v_cvt_pk_bf16_f32 v32, v33, v34
    v_lshlrev_b32 v33, 16, v32
    v_and_b32 v34, 0xffff0000, v32
    v_add_f32 v33, v33, v194
    v_add_f32 v34, v34, v195
    v_cvt_pk_bf16_f32 v45, v33, v34
    buffer_store_dword v45, v3, s[20:23], s15 offen offset:1024
    v_cvt_pk_bf16_f32 v36, v18, v22
    v_lshlrev_b32 v37, 16, v36
    v_and_b32 v38, 0xffff0000, v36
    v_add_f32 v37, v37, v188
    v_add_f32 v38, v38, v189
    v_cvt_pk_bf16_f32 v36, v37, v38
    v_lshlrev_b32 v37, 16, v36
    v_and_b32 v38, 0xffff0000, v36
    v_add_f32 v37, v37, v196
    v_add_f32 v38, v38, v197
    v_cvt_pk_bf16_f32 v46, v37, v38
    buffer_store_dword v46, v3, s[20:23], s15 offen offset:2048
    v_cvt_pk_bf16_f32 v40, v19, v23
    v_lshlrev_b32 v41, 16, v40
    v_and_b32 v42, 0xffff0000, v40
    v_add_f32 v41, v41, v190
    v_add_f32 v42, v42, v191
    v_cvt_pk_bf16_f32 v40, v41, v42
    v_lshlrev_b32 v41, 16, v40
    v_and_b32 v42, 0xffff0000, v40
    v_add_f32 v41, v41, v198
    v_add_f32 v42, v42, v199
    v_cvt_pk_bf16_f32 v47, v41, v42
    buffer_store_dword v47, v3, s[20:23], s15 offen offset:3072
L_convB2_kernel_end:
    s_endpgm

L_code_end:
    s_endpgm
.section .rodata,"a"
.p2align 6
.amdhsa_kernel kv_kernel
  .amdhsa_next_free_vgpr 80
  .amdhsa_next_free_sgpr 72
  .amdhsa_accum_offset 80
  .amdhsa_group_segment_fixed_size 0
  .amdhsa_kernarg_size 128
  .amdhsa_user_sgpr_count 2
  .amdhsa_user_sgpr_kernarg_segment_ptr 1
  .amdhsa_system_sgpr_workgroup_id_x 1
  .amdhsa_float_denorm_mode_32 3
  .amdhsa_float_denorm_mode_16_64 3
.end_amdhsa_kernel

.p2align 6
.amdhsa_kernel convA_kernel
  .amdhsa_next_free_vgpr 212
  .amdhsa_next_free_sgpr 72
  .amdhsa_accum_offset 212
  .amdhsa_group_segment_fixed_size 0
  .amdhsa_kernarg_size 128
  .amdhsa_user_sgpr_count 2
  .amdhsa_user_sgpr_kernarg_segment_ptr 1
  .amdhsa_system_sgpr_workgroup_id_x 1
  .amdhsa_float_denorm_mode_32 3
  .amdhsa_float_denorm_mode_16_64 3
.end_amdhsa_kernel

.p2align 6
.amdhsa_kernel row1_kernel
  .amdhsa_next_free_vgpr 80
  .amdhsa_next_free_sgpr 72
  .amdhsa_accum_offset 80
  .amdhsa_group_segment_fixed_size 0
  .amdhsa_kernarg_size 128
  .amdhsa_user_sgpr_count 2
  .amdhsa_user_sgpr_kernarg_segment_ptr 1
  .amdhsa_system_sgpr_workgroup_id_x 1
  .amdhsa_float_denorm_mode_32 3
  .amdhsa_float_denorm_mode_16_64 3
.end_amdhsa_kernel

.p2align 6
.amdhsa_kernel convB1_kernel
  .amdhsa_next_free_vgpr 212
  .amdhsa_next_free_sgpr 72
  .amdhsa_accum_offset 212
  .amdhsa_group_segment_fixed_size 0
  .amdhsa_kernarg_size 128
  .amdhsa_user_sgpr_count 2
  .amdhsa_user_sgpr_kernarg_segment_ptr 1
  .amdhsa_system_sgpr_workgroup_id_x 1
  .amdhsa_float_denorm_mode_32 3
  .amdhsa_float_denorm_mode_16_64 3
.end_amdhsa_kernel

.p2align 6
.amdhsa_kernel row2_kernel
  .amdhsa_next_free_vgpr 80
  .amdhsa_next_free_sgpr 72
  .amdhsa_accum_offset 80
  .amdhsa_group_segment_fixed_size 0
  .amdhsa_kernarg_size 128
  .amdhsa_user_sgpr_count 2
  .amdhsa_user_sgpr_kernarg_segment_ptr 1
  .amdhsa_system_sgpr_workgroup_id_x 1
  .amdhsa_float_denorm_mode_32 3
  .amdhsa_float_denorm_mode_16_64 3
.end_amdhsa_kernel

.p2align 6
.amdhsa_kernel convB2_kernel
  .amdhsa_next_free_vgpr 212
  .amdhsa_next_free_sgpr 72
  .amdhsa_accum_offset 212
  .amdhsa_group_segment_fixed_size 0
  .amdhsa_kernarg_size 128
  .amdhsa_user_sgpr_count 2
  .amdhsa_user_sgpr_kernarg_segment_ptr 1
  .amdhsa_system_sgpr_workgroup_id_x 1
  .amdhsa_float_denorm_mode_32 3
  .amdhsa_float_denorm_mode_16_64 3
.end_amdhsa_kernel
```
